```python
import torch

def _softmax(x, axis=-1):
    return torch.softmax(x, dim=axis)
def _gelu(x):
    return torch.nn.functional.gelu(x, approximate="tanh")
def _silu(x):
    return torch.nn.functional.silu(x)
def _sigmoid(x):
    return torch.sigmoid(x)
def _layernorm(x, axis=-1, eps=1e-5):
    m = x.mean(dim=axis, keepdim=True)
    v = x.var(dim=axis, keepdim=True, unbiased=False)
    return (x - m) / torch.sqrt(v + eps)
def _scatter_add(tgt, idx, src, axis=0):
    return tgt.clone().index_add_(axis, idx, src)
def _segment_sum(src, seg, n):
    out = torch.zeros((n,) + src.shape[1:], dtype=src.dtype)
    return out.index_add_(0, seg, src)
def _pad(x, pw):
    flat = tuple(v for pair in reversed(pw) for v in pair)
    return torch.nn.functional.pad(x, flat)

kernel_name = 'standalone__gqa_softmax__prompt'

def setup_inputs():

    _w = (lambda a: (lambda t: t.to(torch.bfloat16) if t.is_floating_point() else t)(torch.as_tensor(a)))
    B, Hq, Hkv, Sq, Sk, D = 1, 32, 32, 2048, 2048, 128
    return {
        "q": _w((lambda *s: torch.randn(*s, dtype=torch.bfloat16) * 0.8)(B, Hq, Sq, D)),
        "k": _w((lambda *s: torch.randn(*s, dtype=torch.bfloat16) * 0.8)(B, Hkv, Sk, D)),
        "v": _w((lambda *s: torch.randn(*s, dtype=torch.bfloat16) * 0.05)(B, Hkv, Sk, D)),
    }

def reference(q, k, v):
    B, Hq, Sq, D = q.shape
    Hkv = k.shape[1]
    rep = Hq // Hkv
    k = (lambda x, n, axis: torch.repeat_interleave(x, n, dim=axis))(k, rep, axis=1)
    v = (lambda x, n, axis: torch.repeat_interleave(x, n, dim=axis))(v, rep, axis=1)
    scale = D ** -0.5
    scores = torch.einsum("bhqd,bhkd->bhqk", q, k) * scale
    p = _softmax(scores, axis=-1)
    return torch.einsum("bhqk,bhkd->bhqd", p, v)
```

```asm
; @launch grid=(256,1,1) block=(256,1,1) lds=65536
.amdgcn_target "amdgcn-amd-amdhsa--gfx950"
.text
.globl standalone__gqa_softmax__prompt_kernel
.p2align 8
.type standalone__gqa_softmax__prompt_kernel,@function
standalone__gqa_softmax__prompt_kernel:
s_cmp_ge_u32 s2, 256
s_cbranch_scc1 L_END
s_load_dwordx4 s[4:7], s[0:1], 0
s_load_dwordx4 s[8:11], s[0:1], 16
s_and_b32 s12, s2, 7
s_lshr_b32 s13, s2, 3
s_and_b32 s33, s13, 3
s_lshl_b32 s12, s12, 2
s_or_b32 s12, s12, s33
s_lshr_b32 s13, s13, 2
v_lshrrev_b32 v38, 6, v0
v_and_b32 v1, 63, v0
v_readfirstlane_b32 s14, v38
s_waitcnt lgkmcnt(0)
s_lshl_b32 s34, s12, 11
s_lshl_b32 s35, s13, 8
s_add_u32 s34, s34, s35
s_lshl_b32 s35, s14, 6
s_add_u32 s34, s34, s35
s_lshl_b32 s34, s34, 8
s_add_u32 s24, s4, s34
s_addc_u32 s25, s5, 0
s_mov_b32 s26, 16384
s_mov_b32 s27, 0x00020000
s_mov_b32 s36, 4096
s_mov_b32 s37, 8192
s_mov_b32 s38, 12288
v_and_b32 v26, 15, v1
v_lshrrev_b32 v27, 4, v1
v_lshlrev_b32 v28, 8, v26
v_lshl_add_u32 v28, v27, 4, v28
buffer_load_dwordx4 v[152:155], v28, s[24:27], 0 offen offset:0
buffer_load_dwordx4 v[156:159], v28, s[24:27], 0 offen offset:64
buffer_load_dwordx4 v[160:163], v28, s[24:27], 0 offen offset:128
buffer_load_dwordx4 v[164:167], v28, s[24:27], 0 offen offset:192
buffer_load_dwordx4 v[168:171], v28, s[24:27], s36 offen offset:0
buffer_load_dwordx4 v[172:175], v28, s[24:27], s36 offen offset:64
buffer_load_dwordx4 v[176:179], v28, s[24:27], s36 offen offset:128
buffer_load_dwordx4 v[180:183], v28, s[24:27], s36 offen offset:192
buffer_load_dwordx4 v[184:187], v28, s[24:27], s37 offen offset:0
buffer_load_dwordx4 v[188:191], v28, s[24:27], s37 offen offset:64
buffer_load_dwordx4 v[192:195], v28, s[24:27], s37 offen offset:128
buffer_load_dwordx4 v[196:199], v28, s[24:27], s37 offen offset:192
buffer_load_dwordx4 v[200:203], v28, s[24:27], s38 offen offset:0
buffer_load_dwordx4 v[204:207], v28, s[24:27], s38 offen offset:64
buffer_load_dwordx4 v[208:211], v28, s[24:27], s38 offen offset:128
buffer_load_dwordx4 v[212:215], v28, s[24:27], s38 offen offset:192
s_mul_i32 s33, s12, 0x80000
s_add_u32 s16, s6, s33
s_addc_u32 s17, s7, 0
s_mov_b32 s18, 0x80000
s_mov_b32 s19, 0x00020000
s_add_u32 s20, s8, s33
s_addc_u32 s21, s9, 0
s_mov_b32 s22, 0x80000
s_mov_b32 s23, 0x00020000
v_lshrrev_b32 v29, 4, v1
v_and_b32 v30, 15, v1
v_lshl_add_u32 v31, v38, 3, v29
v_add_u32 v32, 0, v31
v_and_b32 v33, 15, v32
v_xor_b32 v33, v33, v30
v_lshlrev_b32 v33, 4, v33
v_lshl_add_u32 v33, v32, 8, v33
v_subrev_u32 v14, 0, v33
v_and_b32 v33, 7, v32
v_lshlrev_b32 v33, 1, v33
v_xor_b32 v33, v33, v30
v_lshlrev_b32 v33, 4, v33
v_lshl_add_u32 v33, v32, 8, v33
v_subrev_u32 v16, 0, v33
v_add_u32 v32, 4, v31
v_and_b32 v33, 15, v32
v_xor_b32 v33, v33, v30
v_lshlrev_b32 v33, 4, v33
v_lshl_add_u32 v33, v32, 8, v33
v_subrev_u32 v15, 1024, v33
v_and_b32 v33, 7, v32
v_lshlrev_b32 v33, 1, v33
v_xor_b32 v33, v33, v30
v_lshlrev_b32 v33, 4, v33
v_lshl_add_u32 v33, v32, 8, v33
v_subrev_u32 v17, 1024, v33
s_lshl_b32 s30, s14, 11
s_mov_b32 s28, 0
s_mov_b32 s29, 0
s_add_u32 m0, s30, 0
s_nop 0
buffer_load_dwordx4 v14, s[16:19], s28 offen lds
buffer_load_dwordx4 v15, s[16:19], s28 offen offset:1024 lds
s_add_u32 s28, s28, 8192
s_add_u32 m0, s30, 8192
s_nop 0
buffer_load_dwordx4 v14, s[16:19], s28 offen lds
buffer_load_dwordx4 v15, s[16:19], s28 offen offset:1024 lds
s_add_u32 s28, s28, 8192
s_add_u32 m0, s30, 16384
s_nop 0
buffer_load_dwordx4 v14, s[16:19], s28 offen lds
buffer_load_dwordx4 v15, s[16:19], s28 offen offset:1024 lds
s_add_u32 s28, s28, 8192
s_add_u32 m0, s30, 32768
s_nop 0
buffer_load_dwordx4 v16, s[20:23], s29 offen lds
buffer_load_dwordx4 v17, s[20:23], s29 offen offset:1024 lds
s_add_u32 s29, s29, 8192
v_add_u32 v29, 0, v27
v_xor_b32 v29, v29, v26
v_lshlrev_b32 v29, 4, v29
v_lshl_add_u32 v2, v26, 8, v29
v_add_u32 v29, 4, v27
v_xor_b32 v29, v29, v26
v_lshlrev_b32 v29, 4, v29
v_lshl_add_u32 v3, v26, 8, v29
v_add_u32 v29, 8, v27
v_xor_b32 v29, v29, v26
v_lshlrev_b32 v29, 4, v29
v_lshl_add_u32 v4, v26, 8, v29
v_add_u32 v29, 12, v27
v_xor_b32 v29, v29, v26
v_lshlrev_b32 v29, 4, v29
v_lshl_add_u32 v5, v26, 8, v29
v_bfe_u32 v29, v1, 2, 2
v_and_b32 v30, 3, v1
v_lshl_add_u32 v31, v27, 2, v29
v_and_b32 v32, 7, v31
v_lshlrev_b32 v31, 8, v31
v_lshl_add_u32 v31, v30, 3, v31
v_xor_b32 v33, 0, v32
v_lshl_add_u32 v6, v33, 5, v31
v_xor_b32 v33, 1, v32
v_lshl_add_u32 v7, v33, 5, v31
v_xor_b32 v33, 2, v32
v_lshl_add_u32 v8, v33, 5, v31
v_xor_b32 v33, 3, v32
v_lshl_add_u32 v9, v33, 5, v31
v_xor_b32 v33, 4, v32
v_lshl_add_u32 v10, v33, 5, v31
v_xor_b32 v33, 5, v32
v_lshl_add_u32 v11, v33, 5, v31
v_xor_b32 v33, 6, v32
v_lshl_add_u32 v12, v33, 5, v31
v_xor_b32 v33, 7, v32
v_lshl_add_u32 v13, v33, 5, v31
v_mov_b32 v32, 0
v_mov_b32 v33, 0
v_mov_b32 v34, 0
v_mov_b32 v35, 0
v_lshlrev_b32 v29, 4, v0
ds_write_b128 v29, v[32:35] offset:57344
ds_write_b128 v29, v[32:35] offset:61440
v_accvgpr_write_b32 a0, 0
v_accvgpr_write_b32 a1, 0
v_accvgpr_write_b32 a2, 0
v_accvgpr_write_b32 a3, 0
v_accvgpr_write_b32 a4, 0
v_accvgpr_write_b32 a5, 0
v_accvgpr_write_b32 a6, 0
v_accvgpr_write_b32 a7, 0
v_accvgpr_write_b32 a8, 0
v_accvgpr_write_b32 a9, 0
v_accvgpr_write_b32 a10, 0
v_accvgpr_write_b32 a11, 0
v_accvgpr_write_b32 a12, 0
v_accvgpr_write_b32 a13, 0
v_accvgpr_write_b32 a14, 0
v_accvgpr_write_b32 a15, 0
v_accvgpr_write_b32 a16, 0
v_accvgpr_write_b32 a17, 0
v_accvgpr_write_b32 a18, 0
v_accvgpr_write_b32 a19, 0
v_accvgpr_write_b32 a20, 0
v_accvgpr_write_b32 a21, 0
v_accvgpr_write_b32 a22, 0
v_accvgpr_write_b32 a23, 0
v_accvgpr_write_b32 a24, 0
v_accvgpr_write_b32 a25, 0
v_accvgpr_write_b32 a26, 0
v_accvgpr_write_b32 a27, 0
v_accvgpr_write_b32 a28, 0
v_accvgpr_write_b32 a29, 0
v_accvgpr_write_b32 a30, 0
v_accvgpr_write_b32 a31, 0
v_accvgpr_write_b32 a32, 0
v_accvgpr_write_b32 a33, 0
v_accvgpr_write_b32 a34, 0
v_accvgpr_write_b32 a35, 0
v_accvgpr_write_b32 a36, 0
v_accvgpr_write_b32 a37, 0
v_accvgpr_write_b32 a38, 0
v_accvgpr_write_b32 a39, 0
v_accvgpr_write_b32 a40, 0
v_accvgpr_write_b32 a41, 0
v_accvgpr_write_b32 a42, 0
v_accvgpr_write_b32 a43, 0
v_accvgpr_write_b32 a44, 0
v_accvgpr_write_b32 a45, 0
v_accvgpr_write_b32 a46, 0
v_accvgpr_write_b32 a47, 0
v_accvgpr_write_b32 a48, 0
v_accvgpr_write_b32 a49, 0
v_accvgpr_write_b32 a50, 0
v_accvgpr_write_b32 a51, 0
v_accvgpr_write_b32 a52, 0
v_accvgpr_write_b32 a53, 0
v_accvgpr_write_b32 a54, 0
v_accvgpr_write_b32 a55, 0
v_accvgpr_write_b32 a56, 0
v_accvgpr_write_b32 a57, 0
v_accvgpr_write_b32 a58, 0
v_accvgpr_write_b32 a59, 0
v_accvgpr_write_b32 a60, 0
v_accvgpr_write_b32 a61, 0
v_accvgpr_write_b32 a62, 0
v_accvgpr_write_b32 a63, 0
v_accvgpr_write_b32 a64, 0
v_accvgpr_write_b32 a65, 0
v_accvgpr_write_b32 a66, 0
v_accvgpr_write_b32 a67, 0
v_accvgpr_write_b32 a68, 0
v_accvgpr_write_b32 a69, 0
v_accvgpr_write_b32 a70, 0
v_accvgpr_write_b32 a71, 0
v_accvgpr_write_b32 a72, 0
v_accvgpr_write_b32 a73, 0
v_accvgpr_write_b32 a74, 0
v_accvgpr_write_b32 a75, 0
v_accvgpr_write_b32 a76, 0
v_accvgpr_write_b32 a77, 0
v_accvgpr_write_b32 a78, 0
v_accvgpr_write_b32 a79, 0
v_accvgpr_write_b32 a80, 0
v_accvgpr_write_b32 a81, 0
v_accvgpr_write_b32 a82, 0
v_accvgpr_write_b32 a83, 0
v_accvgpr_write_b32 a84, 0
v_accvgpr_write_b32 a85, 0
v_accvgpr_write_b32 a86, 0
v_accvgpr_write_b32 a87, 0
v_accvgpr_write_b32 a88, 0
v_accvgpr_write_b32 a89, 0
v_accvgpr_write_b32 a90, 0
v_accvgpr_write_b32 a91, 0
v_accvgpr_write_b32 a92, 0
v_accvgpr_write_b32 a93, 0
v_accvgpr_write_b32 a94, 0
v_accvgpr_write_b32 a95, 0
v_accvgpr_write_b32 a96, 0
v_accvgpr_write_b32 a97, 0
v_accvgpr_write_b32 a98, 0
v_accvgpr_write_b32 a99, 0
v_accvgpr_write_b32 a100, 0
v_accvgpr_write_b32 a101, 0
v_accvgpr_write_b32 a102, 0
v_accvgpr_write_b32 a103, 0
v_accvgpr_write_b32 a104, 0
v_accvgpr_write_b32 a105, 0
v_accvgpr_write_b32 a106, 0
v_accvgpr_write_b32 a107, 0
v_accvgpr_write_b32 a108, 0
v_accvgpr_write_b32 a109, 0
v_accvgpr_write_b32 a110, 0
v_accvgpr_write_b32 a111, 0
v_accvgpr_write_b32 a112, 0
v_accvgpr_write_b32 a113, 0
v_accvgpr_write_b32 a114, 0
v_accvgpr_write_b32 a115, 0
v_accvgpr_write_b32 a116, 0
v_accvgpr_write_b32 a117, 0
v_accvgpr_write_b32 a118, 0
v_accvgpr_write_b32 a119, 0
v_accvgpr_write_b32 a120, 0
v_accvgpr_write_b32 a121, 0
v_accvgpr_write_b32 a122, 0
v_accvgpr_write_b32 a123, 0
v_accvgpr_write_b32 a124, 0
v_accvgpr_write_b32 a125, 0
v_accvgpr_write_b32 a126, 0
v_accvgpr_write_b32 a127, 0
v_mov_b32 v120, 0
v_mov_b32 v121, 0
v_mov_b32 v122, 0
v_mov_b32 v123, 0
v_mov_b32 v124, 0
v_mov_b32 v125, 0
v_mov_b32 v126, 0
v_mov_b32 v127, 0
v_mov_b32 v128, 0
v_mov_b32 v129, 0
v_mov_b32 v130, 0
v_mov_b32 v131, 0
v_mov_b32 v132, 0
v_mov_b32 v133, 0
v_mov_b32 v134, 0
v_mov_b32 v135, 0
v_mov_b32 v18, 0
v_mov_b32 v19, 0
v_mov_b32 v20, 0
v_mov_b32 v21, 0
s_mov_b32 s32, 0x46800000
s_mov_b32 s34, 0x3e0293ee
s_waitcnt vmcnt(8)
v_lshlrev_b32 v29, 16, v152
v_and_b32 v30, 0xffff0000, v152
v_mul_f32 v29, s34, v29
v_mul_f32 v30, s34, v30
v_cvt_pk_bf16_f32 v31, v29, v30
v_accvgpr_write_b32 a128, v31
v_lshlrev_b32 v29, 16, v153
v_and_b32 v30, 0xffff0000, v153
v_mul_f32 v29, s34, v29
v_mul_f32 v30, s34, v30
v_cvt_pk_bf16_f32 v31, v29, v30
v_accvgpr_write_b32 a129, v31
v_lshlrev_b32 v29, 16, v154
v_and_b32 v30, 0xffff0000, v154
v_mul_f32 v29, s34, v29
v_mul_f32 v30, s34, v30
v_cvt_pk_bf16_f32 v31, v29, v30
v_accvgpr_write_b32 a130, v31
v_lshlrev_b32 v29, 16, v155
v_and_b32 v30, 0xffff0000, v155
v_mul_f32 v29, s34, v29
v_mul_f32 v30, s34, v30
v_cvt_pk_bf16_f32 v31, v29, v30
v_accvgpr_write_b32 a131, v31
v_lshlrev_b32 v29, 16, v156
v_and_b32 v30, 0xffff0000, v156
v_mul_f32 v29, s34, v29
v_mul_f32 v30, s34, v30
v_cvt_pk_bf16_f32 v31, v29, v30
v_accvgpr_write_b32 a132, v31
v_lshlrev_b32 v29, 16, v157
v_and_b32 v30, 0xffff0000, v157
v_mul_f32 v29, s34, v29
v_mul_f32 v30, s34, v30
v_cvt_pk_bf16_f32 v31, v29, v30
v_accvgpr_write_b32 a133, v31
v_lshlrev_b32 v29, 16, v158
v_and_b32 v30, 0xffff0000, v158
v_mul_f32 v29, s34, v29
v_mul_f32 v30, s34, v30
v_cvt_pk_bf16_f32 v31, v29, v30
v_accvgpr_write_b32 a134, v31
v_lshlrev_b32 v29, 16, v159
v_and_b32 v30, 0xffff0000, v159
v_mul_f32 v29, s34, v29
v_mul_f32 v30, s34, v30
v_cvt_pk_bf16_f32 v31, v29, v30
v_accvgpr_write_b32 a135, v31
v_lshlrev_b32 v29, 16, v160
v_and_b32 v30, 0xffff0000, v160
v_mul_f32 v29, s34, v29
v_mul_f32 v30, s34, v30
v_cvt_pk_bf16_f32 v31, v29, v30
v_accvgpr_write_b32 a136, v31
v_lshlrev_b32 v29, 16, v161
v_and_b32 v30, 0xffff0000, v161
v_mul_f32 v29, s34, v29
v_mul_f32 v30, s34, v30
v_cvt_pk_bf16_f32 v31, v29, v30
v_accvgpr_write_b32 a137, v31
v_lshlrev_b32 v29, 16, v162
v_and_b32 v30, 0xffff0000, v162
v_mul_f32 v29, s34, v29
v_mul_f32 v30, s34, v30
v_cvt_pk_bf16_f32 v31, v29, v30
v_accvgpr_write_b32 a138, v31
v_lshlrev_b32 v29, 16, v163
v_and_b32 v30, 0xffff0000, v163
v_mul_f32 v29, s34, v29
v_mul_f32 v30, s34, v30
v_cvt_pk_bf16_f32 v31, v29, v30
v_accvgpr_write_b32 a139, v31
v_lshlrev_b32 v29, 16, v164
v_and_b32 v30, 0xffff0000, v164
v_mul_f32 v29, s34, v29
v_mul_f32 v30, s34, v30
v_cvt_pk_bf16_f32 v31, v29, v30
v_accvgpr_write_b32 a140, v31
v_lshlrev_b32 v29, 16, v165
v_and_b32 v30, 0xffff0000, v165
v_mul_f32 v29, s34, v29
v_mul_f32 v30, s34, v30
v_cvt_pk_bf16_f32 v31, v29, v30
v_accvgpr_write_b32 a141, v31
v_lshlrev_b32 v29, 16, v166
v_and_b32 v30, 0xffff0000, v166
v_mul_f32 v29, s34, v29
v_mul_f32 v30, s34, v30
v_cvt_pk_bf16_f32 v31, v29, v30
v_accvgpr_write_b32 a142, v31
v_lshlrev_b32 v29, 16, v167
v_and_b32 v30, 0xffff0000, v167
v_mul_f32 v29, s34, v29
v_mul_f32 v30, s34, v30
v_cvt_pk_bf16_f32 v31, v29, v30
v_accvgpr_write_b32 a143, v31
v_lshlrev_b32 v29, 16, v168
v_and_b32 v30, 0xffff0000, v168
v_mul_f32 v29, s34, v29
v_mul_f32 v30, s34, v30
v_cvt_pk_bf16_f32 v31, v29, v30
v_accvgpr_write_b32 a144, v31
v_lshlrev_b32 v29, 16, v169
v_and_b32 v30, 0xffff0000, v169
v_mul_f32 v29, s34, v29
v_mul_f32 v30, s34, v30
v_cvt_pk_bf16_f32 v31, v29, v30
v_accvgpr_write_b32 a145, v31
v_lshlrev_b32 v29, 16, v170
v_and_b32 v30, 0xffff0000, v170
v_mul_f32 v29, s34, v29
v_mul_f32 v30, s34, v30
v_cvt_pk_bf16_f32 v31, v29, v30
v_accvgpr_write_b32 a146, v31
v_lshlrev_b32 v29, 16, v171
v_and_b32 v30, 0xffff0000, v171
v_mul_f32 v29, s34, v29
v_mul_f32 v30, s34, v30
v_cvt_pk_bf16_f32 v31, v29, v30
v_accvgpr_write_b32 a147, v31
v_lshlrev_b32 v29, 16, v172
v_and_b32 v30, 0xffff0000, v172
v_mul_f32 v29, s34, v29
v_mul_f32 v30, s34, v30
v_cvt_pk_bf16_f32 v31, v29, v30
v_accvgpr_write_b32 a148, v31
v_lshlrev_b32 v29, 16, v173
v_and_b32 v30, 0xffff0000, v173
v_mul_f32 v29, s34, v29
v_mul_f32 v30, s34, v30
v_cvt_pk_bf16_f32 v31, v29, v30
v_accvgpr_write_b32 a149, v31
v_lshlrev_b32 v29, 16, v174
v_and_b32 v30, 0xffff0000, v174
v_mul_f32 v29, s34, v29
v_mul_f32 v30, s34, v30
v_cvt_pk_bf16_f32 v31, v29, v30
v_accvgpr_write_b32 a150, v31
v_lshlrev_b32 v29, 16, v175
v_and_b32 v30, 0xffff0000, v175
v_mul_f32 v29, s34, v29
v_mul_f32 v30, s34, v30
v_cvt_pk_bf16_f32 v31, v29, v30
v_accvgpr_write_b32 a151, v31
v_lshlrev_b32 v29, 16, v176
v_and_b32 v30, 0xffff0000, v176
v_mul_f32 v29, s34, v29
v_mul_f32 v30, s34, v30
v_cvt_pk_bf16_f32 v31, v29, v30
v_accvgpr_write_b32 a152, v31
v_lshlrev_b32 v29, 16, v177
v_and_b32 v30, 0xffff0000, v177
v_mul_f32 v29, s34, v29
v_mul_f32 v30, s34, v30
v_cvt_pk_bf16_f32 v31, v29, v30
v_accvgpr_write_b32 a153, v31
v_lshlrev_b32 v29, 16, v178
v_and_b32 v30, 0xffff0000, v178
v_mul_f32 v29, s34, v29
v_mul_f32 v30, s34, v30
v_cvt_pk_bf16_f32 v31, v29, v30
v_accvgpr_write_b32 a154, v31
v_lshlrev_b32 v29, 16, v179
v_and_b32 v30, 0xffff0000, v179
v_mul_f32 v29, s34, v29
v_mul_f32 v30, s34, v30
v_cvt_pk_bf16_f32 v31, v29, v30
v_accvgpr_write_b32 a155, v31
v_lshlrev_b32 v29, 16, v180
v_and_b32 v30, 0xffff0000, v180
v_mul_f32 v29, s34, v29
v_mul_f32 v30, s34, v30
v_cvt_pk_bf16_f32 v31, v29, v30
v_accvgpr_write_b32 a156, v31
v_lshlrev_b32 v29, 16, v181
v_and_b32 v30, 0xffff0000, v181
v_mul_f32 v29, s34, v29
v_mul_f32 v30, s34, v30
v_cvt_pk_bf16_f32 v31, v29, v30
v_accvgpr_write_b32 a157, v31
v_lshlrev_b32 v29, 16, v182
v_and_b32 v30, 0xffff0000, v182
v_mul_f32 v29, s34, v29
v_mul_f32 v30, s34, v30
v_cvt_pk_bf16_f32 v31, v29, v30
v_accvgpr_write_b32 a158, v31
v_lshlrev_b32 v29, 16, v183
v_and_b32 v30, 0xffff0000, v183
v_mul_f32 v29, s34, v29
v_mul_f32 v30, s34, v30
v_cvt_pk_bf16_f32 v31, v29, v30
v_accvgpr_write_b32 a159, v31
v_lshlrev_b32 v29, 16, v184
v_and_b32 v30, 0xffff0000, v184
v_mul_f32 v29, s34, v29
v_mul_f32 v30, s34, v30
v_cvt_pk_bf16_f32 v31, v29, v30
v_accvgpr_write_b32 a160, v31
v_lshlrev_b32 v29, 16, v185
v_and_b32 v30, 0xffff0000, v185
v_mul_f32 v29, s34, v29
v_mul_f32 v30, s34, v30
v_cvt_pk_bf16_f32 v31, v29, v30
v_accvgpr_write_b32 a161, v31
v_lshlrev_b32 v29, 16, v186
v_and_b32 v30, 0xffff0000, v186
v_mul_f32 v29, s34, v29
v_mul_f32 v30, s34, v30
v_cvt_pk_bf16_f32 v31, v29, v30
v_accvgpr_write_b32 a162, v31
v_lshlrev_b32 v29, 16, v187
v_and_b32 v30, 0xffff0000, v187
v_mul_f32 v29, s34, v29
v_mul_f32 v30, s34, v30
v_cvt_pk_bf16_f32 v31, v29, v30
v_accvgpr_write_b32 a163, v31
v_lshlrev_b32 v29, 16, v188
v_and_b32 v30, 0xffff0000, v188
v_mul_f32 v29, s34, v29
v_mul_f32 v30, s34, v30
v_cvt_pk_bf16_f32 v31, v29, v30
v_accvgpr_write_b32 a164, v31
v_lshlrev_b32 v29, 16, v189
v_and_b32 v30, 0xffff0000, v189
v_mul_f32 v29, s34, v29
v_mul_f32 v30, s34, v30
v_cvt_pk_bf16_f32 v31, v29, v30
v_accvgpr_write_b32 a165, v31
v_lshlrev_b32 v29, 16, v190
v_and_b32 v30, 0xffff0000, v190
v_mul_f32 v29, s34, v29
v_mul_f32 v30, s34, v30
v_cvt_pk_bf16_f32 v31, v29, v30
v_accvgpr_write_b32 a166, v31
v_lshlrev_b32 v29, 16, v191
v_and_b32 v30, 0xffff0000, v191
v_mul_f32 v29, s34, v29
v_mul_f32 v30, s34, v30
v_cvt_pk_bf16_f32 v31, v29, v30
v_accvgpr_write_b32 a167, v31
v_lshlrev_b32 v29, 16, v192
v_and_b32 v30, 0xffff0000, v192
v_mul_f32 v29, s34, v29
v_mul_f32 v30, s34, v30
v_cvt_pk_bf16_f32 v31, v29, v30
v_accvgpr_write_b32 a168, v31
v_lshlrev_b32 v29, 16, v193
v_and_b32 v30, 0xffff0000, v193
v_mul_f32 v29, s34, v29
v_mul_f32 v30, s34, v30
v_cvt_pk_bf16_f32 v31, v29, v30
v_accvgpr_write_b32 a169, v31
v_lshlrev_b32 v29, 16, v194
v_and_b32 v30, 0xffff0000, v194
v_mul_f32 v29, s34, v29
v_mul_f32 v30, s34, v30
v_cvt_pk_bf16_f32 v31, v29, v30
v_accvgpr_write_b32 a170, v31
v_lshlrev_b32 v29, 16, v195
v_and_b32 v30, 0xffff0000, v195
v_mul_f32 v29, s34, v29
v_mul_f32 v30, s34, v30
v_cvt_pk_bf16_f32 v31, v29, v30
v_accvgpr_write_b32 a171, v31
v_lshlrev_b32 v29, 16, v196
v_and_b32 v30, 0xffff0000, v196
v_mul_f32 v29, s34, v29
v_mul_f32 v30, s34, v30
v_cvt_pk_bf16_f32 v31, v29, v30
v_accvgpr_write_b32 a172, v31
v_lshlrev_b32 v29, 16, v197
v_and_b32 v30, 0xffff0000, v197
v_mul_f32 v29, s34, v29
v_mul_f32 v30, s34, v30
v_cvt_pk_bf16_f32 v31, v29, v30
v_accvgpr_write_b32 a173, v31
v_lshlrev_b32 v29, 16, v198
v_and_b32 v30, 0xffff0000, v198
v_mul_f32 v29, s34, v29
v_mul_f32 v30, s34, v30
v_cvt_pk_bf16_f32 v31, v29, v30
v_accvgpr_write_b32 a174, v31
v_lshlrev_b32 v29, 16, v199
v_and_b32 v30, 0xffff0000, v199
v_mul_f32 v29, s34, v29
v_mul_f32 v30, s34, v30
v_cvt_pk_bf16_f32 v31, v29, v30
v_accvgpr_write_b32 a175, v31
v_lshlrev_b32 v29, 16, v200
v_and_b32 v30, 0xffff0000, v200
v_mul_f32 v29, s34, v29
v_mul_f32 v30, s34, v30
v_cvt_pk_bf16_f32 v31, v29, v30
v_accvgpr_write_b32 a176, v31
v_lshlrev_b32 v29, 16, v201
v_and_b32 v30, 0xffff0000, v201
v_mul_f32 v29, s34, v29
v_mul_f32 v30, s34, v30
v_cvt_pk_bf16_f32 v31, v29, v30
v_accvgpr_write_b32 a177, v31
v_lshlrev_b32 v29, 16, v202
v_and_b32 v30, 0xffff0000, v202
v_mul_f32 v29, s34, v29
v_mul_f32 v30, s34, v30
v_cvt_pk_bf16_f32 v31, v29, v30
v_accvgpr_write_b32 a178, v31
v_lshlrev_b32 v29, 16, v203
v_and_b32 v30, 0xffff0000, v203
v_mul_f32 v29, s34, v29
v_mul_f32 v30, s34, v30
v_cvt_pk_bf16_f32 v31, v29, v30
v_accvgpr_write_b32 a179, v31
v_lshlrev_b32 v29, 16, v204
v_and_b32 v30, 0xffff0000, v204
v_mul_f32 v29, s34, v29
v_mul_f32 v30, s34, v30
v_cvt_pk_bf16_f32 v31, v29, v30
v_accvgpr_write_b32 a180, v31
v_lshlrev_b32 v29, 16, v205
v_and_b32 v30, 0xffff0000, v205
v_mul_f32 v29, s34, v29
v_mul_f32 v30, s34, v30
v_cvt_pk_bf16_f32 v31, v29, v30
v_accvgpr_write_b32 a181, v31
v_lshlrev_b32 v29, 16, v206
v_and_b32 v30, 0xffff0000, v206
v_mul_f32 v29, s34, v29
v_mul_f32 v30, s34, v30
v_cvt_pk_bf16_f32 v31, v29, v30
v_accvgpr_write_b32 a182, v31
v_lshlrev_b32 v29, 16, v207
v_and_b32 v30, 0xffff0000, v207
v_mul_f32 v29, s34, v29
v_mul_f32 v30, s34, v30
v_cvt_pk_bf16_f32 v31, v29, v30
v_accvgpr_write_b32 a183, v31
v_lshlrev_b32 v29, 16, v208
v_and_b32 v30, 0xffff0000, v208
v_mul_f32 v29, s34, v29
v_mul_f32 v30, s34, v30
v_cvt_pk_bf16_f32 v31, v29, v30
v_accvgpr_write_b32 a184, v31
v_lshlrev_b32 v29, 16, v209
v_and_b32 v30, 0xffff0000, v209
v_mul_f32 v29, s34, v29
v_mul_f32 v30, s34, v30
v_cvt_pk_bf16_f32 v31, v29, v30
v_accvgpr_write_b32 a185, v31
v_lshlrev_b32 v29, 16, v210
v_and_b32 v30, 0xffff0000, v210
v_mul_f32 v29, s34, v29
v_mul_f32 v30, s34, v30
v_cvt_pk_bf16_f32 v31, v29, v30
v_accvgpr_write_b32 a186, v31
v_lshlrev_b32 v29, 16, v211
v_and_b32 v30, 0xffff0000, v211
v_mul_f32 v29, s34, v29
v_mul_f32 v30, s34, v30
v_cvt_pk_bf16_f32 v31, v29, v30
v_accvgpr_write_b32 a187, v31
v_lshlrev_b32 v29, 16, v212
v_and_b32 v30, 0xffff0000, v212
v_mul_f32 v29, s34, v29
v_mul_f32 v30, s34, v30
v_cvt_pk_bf16_f32 v31, v29, v30
v_accvgpr_write_b32 a188, v31
v_lshlrev_b32 v29, 16, v213
v_and_b32 v30, 0xffff0000, v213
v_mul_f32 v29, s34, v29
v_mul_f32 v30, s34, v30
v_cvt_pk_bf16_f32 v31, v29, v30
v_accvgpr_write_b32 a189, v31
v_lshlrev_b32 v29, 16, v214
v_and_b32 v30, 0xffff0000, v214
v_mul_f32 v29, s34, v29
v_mul_f32 v30, s34, v30
v_cvt_pk_bf16_f32 v31, v29, v30
v_accvgpr_write_b32 a190, v31
v_lshlrev_b32 v29, 16, v215
v_and_b32 v30, 0xffff0000, v215
v_mul_f32 v29, s34, v29
v_mul_f32 v30, s34, v30
v_cvt_pk_bf16_f32 v31, v29, v30
v_accvgpr_write_b32 a191, v31
s_waitcnt vmcnt(0) lgkmcnt(0)
s_barrier
ds_read_b128 v[152:155], v2 offset:0
ds_read_b128 v[156:159], v2 offset:4096
ds_read_b128 v[160:163], v3 offset:0
ds_read_b128 v[164:167], v3 offset:4096
ds_read_b128 v[168:171], v4 offset:0
ds_read_b128 v[172:175], v4 offset:4096
ds_read_b128 v[176:179], v5 offset:0
ds_read_b128 v[180:183], v5 offset:4096
s_waitcnt lgkmcnt(0)
v_mfma_f32_16x16x32_bf16 v[40:43], v[152:155], a[128:131], 0
v_mfma_f32_16x16x32_bf16 v[44:47], v[152:155], a[144:147], 0
v_mfma_f32_16x16x32_bf16 v[48:51], v[152:155], a[160:163], 0
v_mfma_f32_16x16x32_bf16 v[52:55], v[152:155], a[176:179], 0
v_mfma_f32_16x16x32_bf16 v[56:59], v[156:159], a[128:131], 0
v_mfma_f32_16x16x32_bf16 v[60:63], v[156:159], a[144:147], 0
v_mfma_f32_16x16x32_bf16 v[64:67], v[156:159], a[160:163], 0
v_mfma_f32_16x16x32_bf16 v[68:71], v[156:159], a[176:179], 0
v_mfma_f32_16x16x32_bf16 v[40:43], v[160:163], a[132:135], v[40:43]
v_mfma_f32_16x16x32_bf16 v[44:47], v[160:163], a[148:151], v[44:47]
v_mfma_f32_16x16x32_bf16 v[48:51], v[160:163], a[164:167], v[48:51]
v_mfma_f32_16x16x32_bf16 v[52:55], v[160:163], a[180:183], v[52:55]
v_mfma_f32_16x16x32_bf16 v[56:59], v[164:167], a[132:135], v[56:59]
v_mfma_f32_16x16x32_bf16 v[60:63], v[164:167], a[148:151], v[60:63]
v_mfma_f32_16x16x32_bf16 v[64:67], v[164:167], a[164:167], v[64:67]
v_mfma_f32_16x16x32_bf16 v[68:71], v[164:167], a[180:183], v[68:71]
v_mfma_f32_16x16x32_bf16 v[40:43], v[168:171], a[136:139], v[40:43]
v_mfma_f32_16x16x32_bf16 v[44:47], v[168:171], a[152:155], v[44:47]
v_mfma_f32_16x16x32_bf16 v[48:51], v[168:171], a[168:171], v[48:51]
v_mfma_f32_16x16x32_bf16 v[52:55], v[168:171], a[184:187], v[52:55]
v_mfma_f32_16x16x32_bf16 v[56:59], v[172:175], a[136:139], v[56:59]
v_mfma_f32_16x16x32_bf16 v[60:63], v[172:175], a[152:155], v[60:63]
v_mfma_f32_16x16x32_bf16 v[64:67], v[172:175], a[168:171], v[64:67]
v_mfma_f32_16x16x32_bf16 v[68:71], v[172:175], a[184:187], v[68:71]
v_mfma_f32_16x16x32_bf16 v[40:43], v[176:179], a[140:143], v[40:43]
v_mfma_f32_16x16x32_bf16 v[44:47], v[176:179], a[156:159], v[44:47]
v_mfma_f32_16x16x32_bf16 v[48:51], v[176:179], a[172:175], v[48:51]
v_mfma_f32_16x16x32_bf16 v[52:55], v[176:179], a[188:191], v[52:55]
v_mfma_f32_16x16x32_bf16 v[56:59], v[180:183], a[140:143], v[56:59]
v_mfma_f32_16x16x32_bf16 v[60:63], v[180:183], a[156:159], v[60:63]
v_mfma_f32_16x16x32_bf16 v[64:67], v[180:183], a[172:175], v[64:67]
v_mfma_f32_16x16x32_bf16 v[68:71], v[180:183], a[188:191], v[68:71]
s_add_u32 m0, s30, 24576
ds_read_b128 v[152:155], v2 offset:8192
ds_read_b128 v[156:159], v2 offset:12288
ds_read_b64_tr_b16 v[184:185], v6 offset:57344
ds_read_b64_tr_b16 v[186:187], v6 offset:61440
buffer_load_dwordx4 v14, s[16:19], s28 offen lds
s_nop 15
v_max3_f32 v26, v40, v41, v42
v_max3_f32 v26, v26, v43, v56
v_max3_f32 v26, v26, v57, v58
v_max_f32 v26, v26, v59
v_mov_b32 v28, v26
s_nop 1
v_permlane32_swap_b32 v26, v28
s_nop 1
v_max_f32 v26, v26, v28
v_mov_b32 v28, v26
s_nop 1
v_permlane16_swap_b32 v26, v28
s_nop 1
v_max_f32 v26, v26, v28
v_sub_f32 v136, 0, v26
v_sub_f32 v137, 0, v26
v_sub_f32 v138, 0, v26
v_sub_f32 v139, 0, v26
v_sub_f32 v40, v40, v26
v_sub_f32 v41, v41, v26
v_sub_f32 v42, v42, v26
v_sub_f32 v43, v43, v26
v_sub_f32 v56, v56, v26
v_sub_f32 v57, v57, v26
v_sub_f32 v58, v58, v26
v_sub_f32 v59, v59, v26
v_max3_f32 v26, v44, v45, v46
v_max3_f32 v26, v26, v47, v60
v_max3_f32 v26, v26, v61, v62
v_max_f32 v26, v26, v63
v_mov_b32 v28, v26
s_nop 1
v_permlane32_swap_b32 v26, v28
s_nop 1
v_max_f32 v26, v26, v28
v_mov_b32 v28, v26
s_nop 1
v_permlane16_swap_b32 v26, v28
s_nop 1
v_max_f32 v26, v26, v28
v_sub_f32 v140, 0, v26
v_sub_f32 v141, 0, v26
v_sub_f32 v142, 0, v26
v_sub_f32 v143, 0, v26
v_sub_f32 v44, v44, v26
v_sub_f32 v45, v45, v26
v_sub_f32 v46, v46, v26
v_sub_f32 v47, v47, v26
v_sub_f32 v60, v60, v26
v_sub_f32 v61, v61, v26
v_sub_f32 v62, v62, v26
v_sub_f32 v63, v63, v26
v_max3_f32 v26, v48, v49, v50
v_max3_f32 v26, v26, v51, v64
v_max3_f32 v26, v26, v65, v66
v_max_f32 v26, v26, v67
v_mov_b32 v28, v26
s_nop 1
v_permlane32_swap_b32 v26, v28
s_nop 1
v_max_f32 v26, v26, v28
v_mov_b32 v28, v26
s_nop 1
v_permlane16_swap_b32 v26, v28
s_nop 1
v_max_f32 v26, v26, v28
v_sub_f32 v144, 0, v26
v_sub_f32 v145, 0, v26
v_sub_f32 v146, 0, v26
v_sub_f32 v147, 0, v26
v_sub_f32 v48, v48, v26
v_sub_f32 v49, v49, v26
v_sub_f32 v50, v50, v26
v_sub_f32 v51, v51, v26
v_sub_f32 v64, v64, v26
v_sub_f32 v65, v65, v26
v_sub_f32 v66, v66, v26
v_sub_f32 v67, v67, v26
v_max3_f32 v26, v52, v53, v54
v_max3_f32 v26, v26, v55, v68
v_max3_f32 v26, v26, v69, v70
v_max_f32 v26, v26, v71
v_mov_b32 v28, v26
s_nop 1
v_permlane32_swap_b32 v26, v28
s_nop 1
v_max_f32 v26, v26, v28
v_mov_b32 v28, v26
s_nop 1
v_permlane16_swap_b32 v26, v28
s_nop 1
v_max_f32 v26, v26, v28
v_sub_f32 v148, 0, v26
v_sub_f32 v149, 0, v26
v_sub_f32 v150, 0, v26
v_sub_f32 v151, 0, v26
v_sub_f32 v52, v52, v26
v_sub_f32 v53, v53, v26
v_sub_f32 v54, v54, v26
v_sub_f32 v55, v55, v26
v_sub_f32 v68, v68, v26
v_sub_f32 v69, v69, v26
v_sub_f32 v70, v70, v26
v_sub_f32 v71, v71, v26
s_waitcnt lgkmcnt(0)
s_mov_b32 s31, 16
s_nop 1
L_LOOP:
v_mfma_f32_16x16x32_bf16 v[72:75], v[152:155], a[128:131], v[136:139]
ds_read_b64_tr_b16 v[188:189], v7 offset:57344
v_exp_f32 v29, v40
v_mfma_f32_16x16x32_bf16 v[76:79], v[152:155], a[144:147], v[140:143]
ds_read_b64_tr_b16 v[190:191], v7 offset:61440
v_exp_f32 v30, v41
v_mfma_f32_16x16x32_bf16 v[80:83], v[152:155], a[160:163], v[144:147]
buffer_load_dwordx4 v15, s[16:19], s28 offen offset:1024 lds
v_mfma_f32_16x16x32_bf16 v[84:87], v[152:155], a[176:179], v[148:151]
s_waitcnt lgkmcnt(3)
v_add_f32 v22, v29, v30
v_cvt_pk_bf16_f32 v104, v29, v30
v_mfma_f32_16x16x32_bf16 a[0:3], v[184:187], v[120:123], a[0:3]
ds_read_b128 v[160:163], v3 offset:8192
v_exp_f32 v31, v44
v_mfma_f32_16x16x32_bf16 a[4:7], v[184:187], v[124:127], a[4:7]
s_add_u32 s28, s28, 8192
v_exp_f32 v32, v45
v_mfma_f32_16x16x32_bf16 a[8:11], v[184:187], v[128:131], a[8:11]
s_add_u32 m0, s30, 40960
v_add_f32 v23, v31, v32
v_cvt_pk_bf16_f32 v108, v31, v32
v_mfma_f32_16x16x32_bf16 a[12:15], v[184:187], v[132:135], a[12:15]
s_waitcnt lgkmcnt(3)
v_exp_f32 v33, v48
v_mfma_f32_16x16x32_bf16 v[88:91], v[156:159], a[128:131], v[136:139]
ds_read_b64_tr_b16 v[192:193], v8 offset:57344
v_exp_f32 v34, v49
v_mfma_f32_16x16x32_bf16 v[92:95], v[156:159], a[144:147], v[140:143]
ds_read_b64_tr_b16 v[194:195], v8 offset:61440
v_add_f32 v24, v33, v34
v_cvt_pk_bf16_f32 v112, v33, v34
v_mfma_f32_16x16x32_bf16 v[96:99], v[156:159], a[160:163], v[144:147]
buffer_load_dwordx4 v16, s[20:23], s29 offen lds
v_mfma_f32_16x16x32_bf16 v[100:103], v[156:159], a[176:179], v[148:151]
s_waitcnt lgkmcnt(3)
v_exp_f32 v35, v52
v_mfma_f32_16x16x32_bf16 a[16:19], v[188:191], v[120:123], a[16:19]
ds_read_b128 v[164:167], v3 offset:12288
v_exp_f32 v36, v53
v_mfma_f32_16x16x32_bf16 a[20:23], v[188:191], v[124:127], a[20:23]
buffer_load_dwordx4 v17, s[20:23], s29 offen offset:1024 lds
v_mfma_f32_16x16x32_bf16 a[24:27], v[188:191], v[128:131], a[24:27]
s_add_u32 s29, s29, 8192
v_add_f32 v25, v35, v36
v_cvt_pk_bf16_f32 v116, v35, v36
v_mfma_f32_16x16x32_bf16 a[28:31], v[188:191], v[132:135], a[28:31]
s_waitcnt lgkmcnt(3)
v_exp_f32 v29, v42
v_mfma_f32_16x16x32_bf16 v[72:75], v[160:163], a[132:135], v[72:75]
ds_read_b64_tr_b16 v[196:197], v9 offset:57344
v_exp_f32 v30, v43
v_mfma_f32_16x16x32_bf16 v[76:79], v[160:163], a[148:151], v[76:79]
ds_read_b64_tr_b16 v[198:199], v9 offset:61440
v_add_f32 v22, v22, v29
v_add_f32 v22, v22, v30
v_mfma_f32_16x16x32_bf16 v[80:83], v[160:163], a[164:167], v[80:83]
v_cvt_pk_bf16_f32 v105, v29, v30
v_exp_f32 v31, v46
v_mfma_f32_16x16x32_bf16 v[84:87], v[160:163], a[180:183], v[84:87]
s_waitcnt lgkmcnt(3)
v_exp_f32 v32, v47
v_mfma_f32_16x16x32_bf16 a[32:35], v[192:195], v[120:123], a[32:35]
ds_read_b128 v[168:171], v4 offset:8192
v_add_f32 v23, v23, v31
v_add_f32 v23, v23, v32
v_mfma_f32_16x16x32_bf16 a[36:39], v[192:195], v[124:127], a[36:39]
v_cvt_pk_bf16_f32 v109, v31, v32
v_exp_f32 v33, v50
v_mfma_f32_16x16x32_bf16 a[40:43], v[192:195], v[128:131], a[40:43]
v_exp_f32 v34, v51
v_mfma_f32_16x16x32_bf16 a[44:47], v[192:195], v[132:135], a[44:47]
s_waitcnt lgkmcnt(3)
v_add_f32 v24, v24, v33
v_add_f32 v24, v24, v34
v_mfma_f32_16x16x32_bf16 v[88:91], v[164:167], a[132:135], v[88:91]
ds_read_b64_tr_b16 v[200:201], v10 offset:57344
v_cvt_pk_bf16_f32 v113, v33, v34
v_mfma_f32_16x16x32_bf16 v[92:95], v[164:167], a[148:151], v[92:95]
ds_read_b64_tr_b16 v[202:203], v10 offset:61440
v_exp_f32 v35, v54
v_mfma_f32_16x16x32_bf16 v[96:99], v[164:167], a[164:167], v[96:99]
v_exp_f32 v36, v55
v_mfma_f32_16x16x32_bf16 v[100:103], v[164:167], a[180:183], v[100:103]
s_waitcnt lgkmcnt(3)
v_add_f32 v25, v25, v35
v_add_f32 v25, v25, v36
v_mfma_f32_16x16x32_bf16 a[48:51], v[196:199], v[120:123], a[48:51]
ds_read_b128 v[172:175], v4 offset:12288
v_cvt_pk_bf16_f32 v117, v35, v36
v_mfma_f32_16x16x32_bf16 a[52:55], v[196:199], v[124:127], a[52:55]
v_exp_f32 v29, v56
v_mfma_f32_16x16x32_bf16 a[56:59], v[196:199], v[128:131], a[56:59]
v_exp_f32 v30, v57
v_mfma_f32_16x16x32_bf16 a[60:63], v[196:199], v[132:135], a[60:63]
s_waitcnt lgkmcnt(3)
v_add_f32 v22, v22, v29
v_add_f32 v22, v22, v30
v_mfma_f32_16x16x32_bf16 v[72:75], v[168:171], a[136:139], v[72:75]
ds_read_b64_tr_b16 v[204:205], v11 offset:57344
v_cvt_pk_bf16_f32 v106, v29, v30
v_mfma_f32_16x16x32_bf16 v[76:79], v[168:171], a[152:155], v[76:79]
ds_read_b64_tr_b16 v[206:207], v11 offset:61440
v_exp_f32 v31, v60
v_mfma_f32_16x16x32_bf16 v[80:83], v[168:171], a[168:171], v[80:83]
v_exp_f32 v32, v61
v_mfma_f32_16x16x32_bf16 v[84:87], v[168:171], a[184:187], v[84:87]
s_waitcnt lgkmcnt(3)
v_add_f32 v23, v23, v31
v_add_f32 v23, v23, v32
v_mfma_f32_16x16x32_bf16 a[64:67], v[200:203], v[120:123], a[64:67]
ds_read_b128 v[176:179], v5 offset:8192
v_cvt_pk_bf16_f32 v110, v31, v32
v_mfma_f32_16x16x32_bf16 a[68:71], v[200:203], v[124:127], a[68:71]
v_exp_f32 v33, v64
v_mfma_f32_16x16x32_bf16 a[72:75], v[200:203], v[128:131], a[72:75]
v_exp_f32 v34, v65
v_mfma_f32_16x16x32_bf16 a[76:79], v[200:203], v[132:135], a[76:79]
s_waitcnt lgkmcnt(3)
v_add_f32 v24, v24, v33
v_add_f32 v24, v24, v34
v_mfma_f32_16x16x32_bf16 v[88:91], v[172:175], a[136:139], v[88:91]
ds_read_b64_tr_b16 v[208:209], v12 offset:57344
v_cvt_pk_bf16_f32 v114, v33, v34
v_mfma_f32_16x16x32_bf16 v[92:95], v[172:175], a[152:155], v[92:95]
ds_read_b64_tr_b16 v[210:211], v12 offset:61440
v_exp_f32 v35, v68
v_mfma_f32_16x16x32_bf16 v[96:99], v[172:175], a[168:171], v[96:99]
v_exp_f32 v36, v69
v_mfma_f32_16x16x32_bf16 v[100:103], v[172:175], a[184:187], v[100:103]
s_waitcnt lgkmcnt(3)
v_add_f32 v25, v25, v35
v_add_f32 v25, v25, v36
v_mfma_f32_16x16x32_bf16 a[80:83], v[204:207], v[120:123], a[80:83]
ds_read_b128 v[180:183], v5 offset:12288
v_cvt_pk_bf16_f32 v118, v35, v36
v_mfma_f32_16x16x32_bf16 a[84:87], v[204:207], v[124:127], a[84:87]
v_exp_f32 v29, v58
v_mfma_f32_16x16x32_bf16 a[88:91], v[204:207], v[128:131], a[88:91]
v_exp_f32 v30, v59
v_mfma_f32_16x16x32_bf16 a[92:95], v[204:207], v[132:135], a[92:95]
s_waitcnt lgkmcnt(3)
v_add_f32 v22, v22, v29
v_add_f32 v22, v22, v30
v_mfma_f32_16x16x32_bf16 v[72:75], v[176:179], a[140:143], v[72:75]
ds_read_b64_tr_b16 v[212:213], v13 offset:57344
v_cvt_pk_bf16_f32 v107, v29, v30
v_mfma_f32_16x16x32_bf16 v[76:79], v[176:179], a[156:159], v[76:79]
ds_read_b64_tr_b16 v[214:215], v13 offset:61440
v_exp_f32 v31, v62
v_mfma_f32_16x16x32_bf16 v[80:83], v[176:179], a[172:175], v[80:83]
v_exp_f32 v32, v63
v_mfma_f32_16x16x32_bf16 v[84:87], v[176:179], a[188:191], v[84:87]
s_waitcnt lgkmcnt(3)
s_waitcnt vmcnt(4)
s_barrier
v_mfma_f32_16x16x32_bf16 a[96:99], v[208:211], v[120:123], a[96:99]
ds_read_b128 v[152:155], v2 offset:16384
v_add_f32 v23, v23, v31
v_add_f32 v23, v23, v32
v_mfma_f32_16x16x32_bf16 a[100:103], v[208:211], v[124:127], a[100:103]
s_add_u32 m0, s30, 0
v_cvt_pk_bf16_f32 v111, v31, v32
v_mfma_f32_16x16x32_bf16 a[104:107], v[208:211], v[128:131], a[104:107]
buffer_load_dwordx4 v14, s[16:19], s28 offen lds
v_mfma_f32_16x16x32_bf16 a[108:111], v[208:211], v[132:135], a[108:111]
s_waitcnt lgkmcnt(3)
v_exp_f32 v33, v66
v_mfma_f32_16x16x32_bf16 v[88:91], v[180:183], a[140:143], v[88:91]
ds_read_b64_tr_b16 v[184:185], v6 offset:32768
v_exp_f32 v34, v67
v_mfma_f32_16x16x32_bf16 v[92:95], v[180:183], a[156:159], v[92:95]
ds_read_b64_tr_b16 v[186:187], v6 offset:36864
v_add_f32 v24, v24, v33
v_add_f32 v24, v24, v34
v_mfma_f32_16x16x32_bf16 v[96:99], v[180:183], a[172:175], v[96:99]
v_cvt_pk_bf16_f32 v115, v33, v34
v_exp_f32 v35, v70
v_mfma_f32_16x16x32_bf16 v[100:103], v[180:183], a[188:191], v[100:103]
s_waitcnt lgkmcnt(3)
v_exp_f32 v36, v71
v_mfma_f32_16x16x32_bf16 a[112:115], v[212:215], v[120:123], a[112:115]
ds_read_b128 v[156:159], v2 offset:20480
v_add_f32 v25, v25, v35
v_add_f32 v25, v25, v36
v_mfma_f32_16x16x32_bf16 a[116:119], v[212:215], v[124:127], a[116:119]
v_cvt_pk_bf16_f32 v119, v35, v36
v_mfma_f32_16x16x32_bf16 a[120:123], v[212:215], v[128:131], a[120:123]
v_mfma_f32_16x16x32_bf16 a[124:127], v[212:215], v[132:135], a[124:127]
s_waitcnt lgkmcnt(3)
v_max3_f32 v26, v22, v23, v24
v_max_f32 v26, v26, v25
v_cmp_lt_f32 vcc, s32, v26
s_cbranch_vccnz L_RARE_0
L_BACK_0:
v_add_f32 v18, v18, v22
v_add_f32 v19, v19, v23
v_add_f32 v20, v20, v24
v_add_f32 v21, v21, v25
v_mfma_f32_16x16x32_bf16 v[40:43], v[152:155], a[128:131], v[136:139]
ds_read_b64_tr_b16 v[188:189], v7 offset:32768
v_exp_f32 v29, v72
v_mfma_f32_16x16x32_bf16 v[44:47], v[152:155], a[144:147], v[140:143]
ds_read_b64_tr_b16 v[190:191], v7 offset:36864
v_exp_f32 v30, v73
v_mfma_f32_16x16x32_bf16 v[48:51], v[152:155], a[160:163], v[144:147]
buffer_load_dwordx4 v15, s[16:19], s28 offen offset:1024 lds
v_mfma_f32_16x16x32_bf16 v[52:55], v[152:155], a[176:179], v[148:151]
s_waitcnt lgkmcnt(3)
v_add_f32 v22, v29, v30
v_cvt_pk_bf16_f32 v120, v29, v30
v_mfma_f32_16x16x32_bf16 a[0:3], v[184:187], v[104:107], a[0:3]
ds_read_b128 v[160:163], v3 offset:16384
v_exp_f32 v31, v76
v_mfma_f32_16x16x32_bf16 a[4:7], v[184:187], v[108:111], a[4:7]
s_add_u32 s28, s28, 8192
v_exp_f32 v32, v77
v_mfma_f32_16x16x32_bf16 a[8:11], v[184:187], v[112:115], a[8:11]
s_add_u32 m0, s30, 49152
v_add_f32 v23, v31, v32
v_cvt_pk_bf16_f32 v124, v31, v32
v_mfma_f32_16x16x32_bf16 a[12:15], v[184:187], v[116:119], a[12:15]
s_waitcnt lgkmcnt(3)
v_exp_f32 v33, v80
v_mfma_f32_16x16x32_bf16 v[56:59], v[156:159], a[128:131], v[136:139]
ds_read_b64_tr_b16 v[192:193], v8 offset:32768
v_exp_f32 v34, v81
v_mfma_f32_16x16x32_bf16 v[60:63], v[156:159], a[144:147], v[140:143]
ds_read_b64_tr_b16 v[194:195], v8 offset:36864
v_add_f32 v24, v33, v34
v_cvt_pk_bf16_f32 v128, v33, v34
v_mfma_f32_16x16x32_bf16 v[64:67], v[156:159], a[160:163], v[144:147]
buffer_load_dwordx4 v16, s[20:23], s29 offen lds
v_mfma_f32_16x16x32_bf16 v[68:71], v[156:159], a[176:179], v[148:151]
s_waitcnt lgkmcnt(3)
v_exp_f32 v35, v84
v_mfma_f32_16x16x32_bf16 a[16:19], v[188:191], v[104:107], a[16:19]
ds_read_b128 v[164:167], v3 offset:20480
v_exp_f32 v36, v85
v_mfma_f32_16x16x32_bf16 a[20:23], v[188:191], v[108:111], a[20:23]
buffer_load_dwordx4 v17, s[20:23], s29 offen offset:1024 lds
v_mfma_f32_16x16x32_bf16 a[24:27], v[188:191], v[112:115], a[24:27]
s_add_u32 s29, s29, 8192
v_add_f32 v25, v35, v36
v_cvt_pk_bf16_f32 v132, v35, v36
v_mfma_f32_16x16x32_bf16 a[28:31], v[188:191], v[116:119], a[28:31]
s_waitcnt lgkmcnt(3)
v_exp_f32 v29, v74
v_mfma_f32_16x16x32_bf16 v[40:43], v[160:163], a[132:135], v[40:43]
ds_read_b64_tr_b16 v[196:197], v9 offset:32768
v_exp_f32 v30, v75
v_mfma_f32_16x16x32_bf16 v[44:47], v[160:163], a[148:151], v[44:47]
ds_read_b64_tr_b16 v[198:199], v9 offset:36864
v_add_f32 v22, v22, v29
v_add_f32 v22, v22, v30
v_mfma_f32_16x16x32_bf16 v[48:51], v[160:163], a[164:167], v[48:51]
v_cvt_pk_bf16_f32 v121, v29, v30
v_exp_f32 v31, v78
v_mfma_f32_16x16x32_bf16 v[52:55], v[160:163], a[180:183], v[52:55]
s_waitcnt lgkmcnt(3)
v_exp_f32 v32, v79
v_mfma_f32_16x16x32_bf16 a[32:35], v[192:195], v[104:107], a[32:35]
ds_read_b128 v[168:171], v4 offset:16384
v_add_f32 v23, v23, v31
v_add_f32 v23, v23, v32
v_mfma_f32_16x16x32_bf16 a[36:39], v[192:195], v[108:111], a[36:39]
v_cvt_pk_bf16_f32 v125, v31, v32
v_exp_f32 v33, v82
v_mfma_f32_16x16x32_bf16 a[40:43], v[192:195], v[112:115], a[40:43]
v_exp_f32 v34, v83
v_mfma_f32_16x16x32_bf16 a[44:47], v[192:195], v[116:119], a[44:47]
s_waitcnt lgkmcnt(3)
v_add_f32 v24, v24, v33
v_add_f32 v24, v24, v34
v_mfma_f32_16x16x32_bf16 v[56:59], v[164:167], a[132:135], v[56:59]
ds_read_b64_tr_b16 v[200:201], v10 offset:32768
v_cvt_pk_bf16_f32 v129, v33, v34
v_mfma_f32_16x16x32_bf16 v[60:63], v[164:167], a[148:151], v[60:63]
ds_read_b64_tr_b16 v[202:203], v10 offset:36864
v_exp_f32 v35, v86
v_mfma_f32_16x16x32_bf16 v[64:67], v[164:167], a[164:167], v[64:67]
v_exp_f32 v36, v87
v_mfma_f32_16x16x32_bf16 v[68:71], v[164:167], a[180:183], v[68:71]
s_waitcnt lgkmcnt(3)
v_add_f32 v25, v25, v35
v_add_f32 v25, v25, v36
v_mfma_f32_16x16x32_bf16 a[48:51], v[196:199], v[104:107], a[48:51]
ds_read_b128 v[172:175], v4 offset:20480
v_cvt_pk_bf16_f32 v133, v35, v36
v_mfma_f32_16x16x32_bf16 a[52:55], v[196:199], v[108:111], a[52:55]
v_exp_f32 v29, v88
v_mfma_f32_16x16x32_bf16 a[56:59], v[196:199], v[112:115], a[56:59]
v_exp_f32 v30, v89
v_mfma_f32_16x16x32_bf16 a[60:63], v[196:199], v[116:119], a[60:63]
s_waitcnt lgkmcnt(3)
v_add_f32 v22, v22, v29
v_add_f32 v22, v22, v30
v_mfma_f32_16x16x32_bf16 v[40:43], v[168:171], a[136:139], v[40:43]
ds_read_b64_tr_b16 v[204:205], v11 offset:32768
v_cvt_pk_bf16_f32 v122, v29, v30
v_mfma_f32_16x16x32_bf16 v[44:47], v[168:171], a[152:155], v[44:47]
ds_read_b64_tr_b16 v[206:207], v11 offset:36864
v_exp_f32 v31, v92
v_mfma_f32_16x16x32_bf16 v[48:51], v[168:171], a[168:171], v[48:51]
v_exp_f32 v32, v93
v_mfma_f32_16x16x32_bf16 v[52:55], v[168:171], a[184:187], v[52:55]
s_waitcnt lgkmcnt(3)
v_add_f32 v23, v23, v31
v_add_f32 v23, v23, v32
v_mfma_f32_16x16x32_bf16 a[64:67], v[200:203], v[104:107], a[64:67]
ds_read_b128 v[176:179], v5 offset:16384
v_cvt_pk_bf16_f32 v126, v31, v32
v_mfma_f32_16x16x32_bf16 a[68:71], v[200:203], v[108:111], a[68:71]
v_exp_f32 v33, v96
v_mfma_f32_16x16x32_bf16 a[72:75], v[200:203], v[112:115], a[72:75]
v_exp_f32 v34, v97
v_mfma_f32_16x16x32_bf16 a[76:79], v[200:203], v[116:119], a[76:79]
s_waitcnt lgkmcnt(3)
v_add_f32 v24, v24, v33
v_add_f32 v24, v24, v34
v_mfma_f32_16x16x32_bf16 v[56:59], v[172:175], a[136:139], v[56:59]
ds_read_b64_tr_b16 v[208:209], v12 offset:32768
v_cvt_pk_bf16_f32 v130, v33, v34
v_mfma_f32_16x16x32_bf16 v[60:63], v[172:175], a[152:155], v[60:63]
ds_read_b64_tr_b16 v[210:211], v12 offset:36864
v_exp_f32 v35, v100
v_mfma_f32_16x16x32_bf16 v[64:67], v[172:175], a[168:171], v[64:67]
v_exp_f32 v36, v101
v_mfma_f32_16x16x32_bf16 v[68:71], v[172:175], a[184:187], v[68:71]
s_waitcnt lgkmcnt(3)
v_add_f32 v25, v25, v35
v_add_f32 v25, v25, v36
v_mfma_f32_16x16x32_bf16 a[80:83], v[204:207], v[104:107], a[80:83]
ds_read_b128 v[180:183], v5 offset:20480
v_cvt_pk_bf16_f32 v134, v35, v36
v_mfma_f32_16x16x32_bf16 a[84:87], v[204:207], v[108:111], a[84:87]
v_exp_f32 v29, v90
v_mfma_f32_16x16x32_bf16 a[88:91], v[204:207], v[112:115], a[88:91]
v_exp_f32 v30, v91
v_mfma_f32_16x16x32_bf16 a[92:95], v[204:207], v[116:119], a[92:95]
s_waitcnt lgkmcnt(3)
v_add_f32 v22, v22, v29
v_add_f32 v22, v22, v30
v_mfma_f32_16x16x32_bf16 v[40:43], v[176:179], a[140:143], v[40:43]
ds_read_b64_tr_b16 v[212:213], v13 offset:32768
v_cvt_pk_bf16_f32 v123, v29, v30
v_mfma_f32_16x16x32_bf16 v[44:47], v[176:179], a[156:159], v[44:47]
ds_read_b64_tr_b16 v[214:215], v13 offset:36864
v_exp_f32 v31, v94
v_mfma_f32_16x16x32_bf16 v[48:51], v[176:179], a[172:175], v[48:51]
v_exp_f32 v32, v95
v_mfma_f32_16x16x32_bf16 v[52:55], v[176:179], a[188:191], v[52:55]
s_waitcnt lgkmcnt(3)
s_waitcnt vmcnt(4)
s_barrier
v_mfma_f32_16x16x32_bf16 a[96:99], v[208:211], v[104:107], a[96:99]
ds_read_b128 v[152:155], v2 offset:24576
v_add_f32 v23, v23, v31
v_add_f32 v23, v23, v32
v_mfma_f32_16x16x32_bf16 a[100:103], v[208:211], v[108:111], a[100:103]
s_add_u32 m0, s30, 8192
v_cvt_pk_bf16_f32 v127, v31, v32
v_mfma_f32_16x16x32_bf16 a[104:107], v[208:211], v[112:115], a[104:107]
buffer_load_dwordx4 v14, s[16:19], s28 offen lds
v_mfma_f32_16x16x32_bf16 a[108:111], v[208:211], v[116:119], a[108:111]
s_waitcnt lgkmcnt(3)
v_exp_f32 v33, v98
v_mfma_f32_16x16x32_bf16 v[56:59], v[180:183], a[140:143], v[56:59]
ds_read_b64_tr_b16 v[184:185], v6 offset:40960
v_exp_f32 v34, v99
v_mfma_f32_16x16x32_bf16 v[60:63], v[180:183], a[156:159], v[60:63]
ds_read_b64_tr_b16 v[186:187], v6 offset:45056
v_add_f32 v24, v24, v33
v_add_f32 v24, v24, v34
v_mfma_f32_16x16x32_bf16 v[64:67], v[180:183], a[172:175], v[64:67]
v_cvt_pk_bf16_f32 v131, v33, v34
v_exp_f32 v35, v102
v_mfma_f32_16x16x32_bf16 v[68:71], v[180:183], a[188:191], v[68:71]
s_waitcnt lgkmcnt(3)
v_exp_f32 v36, v103
v_mfma_f32_16x16x32_bf16 a[112:115], v[212:215], v[104:107], a[112:115]
ds_read_b128 v[156:159], v2 offset:28672
v_add_f32 v25, v25, v35
v_add_f32 v25, v25, v36
v_mfma_f32_16x16x32_bf16 a[116:119], v[212:215], v[108:111], a[116:119]
v_cvt_pk_bf16_f32 v135, v35, v36
v_mfma_f32_16x16x32_bf16 a[120:123], v[212:215], v[112:115], a[120:123]
v_mfma_f32_16x16x32_bf16 a[124:127], v[212:215], v[116:119], a[124:127]
s_waitcnt lgkmcnt(3)
v_max3_f32 v26, v22, v23, v24
v_max_f32 v26, v26, v25
v_cmp_lt_f32 vcc, s32, v26
s_cbranch_vccnz L_RARE_1
L_BACK_1:
v_add_f32 v18, v18, v22
v_add_f32 v19, v19, v23
v_add_f32 v20, v20, v24
v_add_f32 v21, v21, v25
v_mfma_f32_16x16x32_bf16 v[72:75], v[152:155], a[128:131], v[136:139]
ds_read_b64_tr_b16 v[188:189], v7 offset:40960
v_exp_f32 v29, v40
v_mfma_f32_16x16x32_bf16 v[76:79], v[152:155], a[144:147], v[140:143]
ds_read_b64_tr_b16 v[190:191], v7 offset:45056
v_exp_f32 v30, v41
v_mfma_f32_16x16x32_bf16 v[80:83], v[152:155], a[160:163], v[144:147]
buffer_load_dwordx4 v15, s[16:19], s28 offen offset:1024 lds
v_mfma_f32_16x16x32_bf16 v[84:87], v[152:155], a[176:179], v[148:151]
s_waitcnt lgkmcnt(3)
v_add_f32 v22, v29, v30
v_cvt_pk_bf16_f32 v104, v29, v30
v_mfma_f32_16x16x32_bf16 a[0:3], v[184:187], v[120:123], a[0:3]
ds_read_b128 v[160:163], v3 offset:24576
v_exp_f32 v31, v44
v_mfma_f32_16x16x32_bf16 a[4:7], v[184:187], v[124:127], a[4:7]
s_add_u32 s28, s28, 8192
v_exp_f32 v32, v45
v_mfma_f32_16x16x32_bf16 a[8:11], v[184:187], v[128:131], a[8:11]
s_add_u32 m0, s30, 57344
v_add_f32 v23, v31, v32
v_cvt_pk_bf16_f32 v108, v31, v32
v_mfma_f32_16x16x32_bf16 a[12:15], v[184:187], v[132:135], a[12:15]
s_waitcnt lgkmcnt(3)
v_exp_f32 v33, v48
v_mfma_f32_16x16x32_bf16 v[88:91], v[156:159], a[128:131], v[136:139]
ds_read_b64_tr_b16 v[192:193], v8 offset:40960
v_exp_f32 v34, v49
v_mfma_f32_16x16x32_bf16 v[92:95], v[156:159], a[144:147], v[140:143]
ds_read_b64_tr_b16 v[194:195], v8 offset:45056
v_add_f32 v24, v33, v34
v_cvt_pk_bf16_f32 v112, v33, v34
v_mfma_f32_16x16x32_bf16 v[96:99], v[156:159], a[160:163], v[144:147]
buffer_load_dwordx4 v16, s[20:23], s29 offen lds
v_mfma_f32_16x16x32_bf16 v[100:103], v[156:159], a[176:179], v[148:151]
s_waitcnt lgkmcnt(3)
v_exp_f32 v35, v52
v_mfma_f32_16x16x32_bf16 a[16:19], v[188:191], v[120:123], a[16:19]
ds_read_b128 v[164:167], v3 offset:28672
v_exp_f32 v36, v53
v_mfma_f32_16x16x32_bf16 a[20:23], v[188:191], v[124:127], a[20:23]
buffer_load_dwordx4 v17, s[20:23], s29 offen offset:1024 lds
v_mfma_f32_16x16x32_bf16 a[24:27], v[188:191], v[128:131], a[24:27]
s_add_u32 s29, s29, 8192
v_add_f32 v25, v35, v36
v_cvt_pk_bf16_f32 v116, v35, v36
v_mfma_f32_16x16x32_bf16 a[28:31], v[188:191], v[132:135], a[28:31]
s_waitcnt lgkmcnt(3)
v_exp_f32 v29, v42
v_mfma_f32_16x16x32_bf16 v[72:75], v[160:163], a[132:135], v[72:75]
ds_read_b64_tr_b16 v[196:197], v9 offset:40960
v_exp_f32 v30, v43
v_mfma_f32_16x16x32_bf16 v[76:79], v[160:163], a[148:151], v[76:79]
ds_read_b64_tr_b16 v[198:199], v9 offset:45056
v_add_f32 v22, v22, v29
v_add_f32 v22, v22, v30
v_mfma_f32_16x16x32_bf16 v[80:83], v[160:163], a[164:167], v[80:83]
v_cvt_pk_bf16_f32 v105, v29, v30
v_exp_f32 v31, v46
v_mfma_f32_16x16x32_bf16 v[84:87], v[160:163], a[180:183], v[84:87]
s_waitcnt lgkmcnt(3)
v_exp_f32 v32, v47
v_mfma_f32_16x16x32_bf16 a[32:35], v[192:195], v[120:123], a[32:35]
ds_read_b128 v[168:171], v4 offset:24576
v_add_f32 v23, v23, v31
v_add_f32 v23, v23, v32
v_mfma_f32_16x16x32_bf16 a[36:39], v[192:195], v[124:127], a[36:39]
v_cvt_pk_bf16_f32 v109, v31, v32
v_exp_f32 v33, v50
v_mfma_f32_16x16x32_bf16 a[40:43], v[192:195], v[128:131], a[40:43]
v_exp_f32 v34, v51
v_mfma_f32_16x16x32_bf16 a[44:47], v[192:195], v[132:135], a[44:47]
s_waitcnt lgkmcnt(3)
v_add_f32 v24, v24, v33
v_add_f32 v24, v24, v34
v_mfma_f32_16x16x32_bf16 v[88:91], v[164:167], a[132:135], v[88:91]
ds_read_b64_tr_b16 v[200:201], v10 offset:40960
v_cvt_pk_bf16_f32 v113, v33, v34
v_mfma_f32_16x16x32_bf16 v[92:95], v[164:167], a[148:151], v[92:95]
ds_read_b64_tr_b16 v[202:203], v10 offset:45056
v_exp_f32 v35, v54
v_mfma_f32_16x16x32_bf16 v[96:99], v[164:167], a[164:167], v[96:99]
v_exp_f32 v36, v55
v_mfma_f32_16x16x32_bf16 v[100:103], v[164:167], a[180:183], v[100:103]
s_waitcnt lgkmcnt(3)
v_add_f32 v25, v25, v35
v_add_f32 v25, v25, v36
v_mfma_f32_16x16x32_bf16 a[48:51], v[196:199], v[120:123], a[48:51]
ds_read_b128 v[172:175], v4 offset:28672
v_cvt_pk_bf16_f32 v117, v35, v36
v_mfma_f32_16x16x32_bf16 a[52:55], v[196:199], v[124:127], a[52:55]
v_exp_f32 v29, v56
v_mfma_f32_16x16x32_bf16 a[56:59], v[196:199], v[128:131], a[56:59]
v_exp_f32 v30, v57
v_mfma_f32_16x16x32_bf16 a[60:63], v[196:199], v[132:135], a[60:63]
s_waitcnt lgkmcnt(3)
v_add_f32 v22, v22, v29
v_add_f32 v22, v22, v30
v_mfma_f32_16x16x32_bf16 v[72:75], v[168:171], a[136:139], v[72:75]
ds_read_b64_tr_b16 v[204:205], v11 offset:40960
v_cvt_pk_bf16_f32 v106, v29, v30
v_mfma_f32_16x16x32_bf16 v[76:79], v[168:171], a[152:155], v[76:79]
ds_read_b64_tr_b16 v[206:207], v11 offset:45056
v_exp_f32 v31, v60
v_mfma_f32_16x16x32_bf16 v[80:83], v[168:171], a[168:171], v[80:83]
v_exp_f32 v32, v61
v_mfma_f32_16x16x32_bf16 v[84:87], v[168:171], a[184:187], v[84:87]
s_waitcnt lgkmcnt(3)
v_add_f32 v23, v23, v31
v_add_f32 v23, v23, v32
v_mfma_f32_16x16x32_bf16 a[64:67], v[200:203], v[120:123], a[64:67]
ds_read_b128 v[176:179], v5 offset:24576
v_cvt_pk_bf16_f32 v110, v31, v32
v_mfma_f32_16x16x32_bf16 a[68:71], v[200:203], v[124:127], a[68:71]
v_exp_f32 v33, v64
v_mfma_f32_16x16x32_bf16 a[72:75], v[200:203], v[128:131], a[72:75]
v_exp_f32 v34, v65
v_mfma_f32_16x16x32_bf16 a[76:79], v[200:203], v[132:135], a[76:79]
s_waitcnt lgkmcnt(3)
v_add_f32 v24, v24, v33
v_add_f32 v24, v24, v34
v_mfma_f32_16x16x32_bf16 v[88:91], v[172:175], a[136:139], v[88:91]
ds_read_b64_tr_b16 v[208:209], v12 offset:40960
v_cvt_pk_bf16_f32 v114, v33, v34
v_mfma_f32_16x16x32_bf16 v[92:95], v[172:175], a[152:155], v[92:95]
ds_read_b64_tr_b16 v[210:211], v12 offset:45056
v_exp_f32 v35, v68
v_mfma_f32_16x16x32_bf16 v[96:99], v[172:175], a[168:171], v[96:99]
v_exp_f32 v36, v69
v_mfma_f32_16x16x32_bf16 v[100:103], v[172:175], a[184:187], v[100:103]
s_waitcnt lgkmcnt(3)
v_add_f32 v25, v25, v35
v_add_f32 v25, v25, v36
v_mfma_f32_16x16x32_bf16 a[80:83], v[204:207], v[120:123], a[80:83]
ds_read_b128 v[180:183], v5 offset:28672
v_cvt_pk_bf16_f32 v118, v35, v36
v_mfma_f32_16x16x32_bf16 a[84:87], v[204:207], v[124:127], a[84:87]
v_exp_f32 v29, v58
v_mfma_f32_16x16x32_bf16 a[88:91], v[204:207], v[128:131], a[88:91]
v_exp_f32 v30, v59
v_mfma_f32_16x16x32_bf16 a[92:95], v[204:207], v[132:135], a[92:95]
s_waitcnt lgkmcnt(3)
v_add_f32 v22, v22, v29
v_add_f32 v22, v22, v30
v_mfma_f32_16x16x32_bf16 v[72:75], v[176:179], a[140:143], v[72:75]
ds_read_b64_tr_b16 v[212:213], v13 offset:40960
v_cvt_pk_bf16_f32 v107, v29, v30
v_mfma_f32_16x16x32_bf16 v[76:79], v[176:179], a[156:159], v[76:79]
ds_read_b64_tr_b16 v[214:215], v13 offset:45056
v_exp_f32 v31, v62
v_mfma_f32_16x16x32_bf16 v[80:83], v[176:179], a[172:175], v[80:83]
v_exp_f32 v32, v63
v_mfma_f32_16x16x32_bf16 v[84:87], v[176:179], a[188:191], v[84:87]
s_waitcnt lgkmcnt(3)
s_waitcnt vmcnt(4)
s_barrier
v_mfma_f32_16x16x32_bf16 a[96:99], v[208:211], v[120:123], a[96:99]
ds_read_b128 v[152:155], v2 offset:0
v_add_f32 v23, v23, v31
v_add_f32 v23, v23, v32
v_mfma_f32_16x16x32_bf16 a[100:103], v[208:211], v[124:127], a[100:103]
s_add_u32 m0, s30, 16384
v_cvt_pk_bf16_f32 v111, v31, v32
v_mfma_f32_16x16x32_bf16 a[104:107], v[208:211], v[128:131], a[104:107]
buffer_load_dwordx4 v14, s[16:19], s28 offen lds
v_mfma_f32_16x16x32_bf16 a[108:111], v[208:211], v[132:135], a[108:111]
s_waitcnt lgkmcnt(3)
v_exp_f32 v33, v66
v_mfma_f32_16x16x32_bf16 v[88:91], v[180:183], a[140:143], v[88:91]
ds_read_b64_tr_b16 v[184:185], v6 offset:49152
v_exp_f32 v34, v67
v_mfma_f32_16x16x32_bf16 v[92:95], v[180:183], a[156:159], v[92:95]
ds_read_b64_tr_b16 v[186:187], v6 offset:53248
v_add_f32 v24, v24, v33
v_add_f32 v24, v24, v34
v_mfma_f32_16x16x32_bf16 v[96:99], v[180:183], a[172:175], v[96:99]
v_cvt_pk_bf16_f32 v115, v33, v34
v_exp_f32 v35, v70
v_mfma_f32_16x16x32_bf16 v[100:103], v[180:183], a[188:191], v[100:103]
s_waitcnt lgkmcnt(3)
v_exp_f32 v36, v71
v_mfma_f32_16x16x32_bf16 a[112:115], v[212:215], v[120:123], a[112:115]
ds_read_b128 v[156:159], v2 offset:4096
v_add_f32 v25, v25, v35
v_add_f32 v25, v25, v36
v_mfma_f32_16x16x32_bf16 a[116:119], v[212:215], v[124:127], a[116:119]
v_cvt_pk_bf16_f32 v119, v35, v36
v_mfma_f32_16x16x32_bf16 a[120:123], v[212:215], v[128:131], a[120:123]
v_mfma_f32_16x16x32_bf16 a[124:127], v[212:215], v[132:135], a[124:127]
s_waitcnt lgkmcnt(3)
v_max3_f32 v26, v22, v23, v24
v_max_f32 v26, v26, v25
v_cmp_lt_f32 vcc, s32, v26
s_cbranch_vccnz L_RARE_2
L_BACK_2:
v_add_f32 v18, v18, v22
v_add_f32 v19, v19, v23
v_add_f32 v20, v20, v24
v_add_f32 v21, v21, v25
v_mfma_f32_16x16x32_bf16 v[40:43], v[152:155], a[128:131], v[136:139]
ds_read_b64_tr_b16 v[188:189], v7 offset:49152
v_exp_f32 v29, v72
v_mfma_f32_16x16x32_bf16 v[44:47], v[152:155], a[144:147], v[140:143]
ds_read_b64_tr_b16 v[190:191], v7 offset:53248
v_exp_f32 v30, v73
v_mfma_f32_16x16x32_bf16 v[48:51], v[152:155], a[160:163], v[144:147]
buffer_load_dwordx4 v15, s[16:19], s28 offen offset:1024 lds
v_mfma_f32_16x16x32_bf16 v[52:55], v[152:155], a[176:179], v[148:151]
s_waitcnt lgkmcnt(3)
v_add_f32 v22, v29, v30
v_cvt_pk_bf16_f32 v120, v29, v30
v_mfma_f32_16x16x32_bf16 a[0:3], v[184:187], v[104:107], a[0:3]
ds_read_b128 v[160:163], v3 offset:0
v_exp_f32 v31, v76
v_mfma_f32_16x16x32_bf16 a[4:7], v[184:187], v[108:111], a[4:7]
s_add_u32 s28, s28, 8192
v_exp_f32 v32, v77
v_mfma_f32_16x16x32_bf16 a[8:11], v[184:187], v[112:115], a[8:11]
s_add_u32 m0, s30, 32768
v_add_f32 v23, v31, v32
v_cvt_pk_bf16_f32 v124, v31, v32
v_mfma_f32_16x16x32_bf16 a[12:15], v[184:187], v[116:119], a[12:15]
s_waitcnt lgkmcnt(3)
v_exp_f32 v33, v80
v_mfma_f32_16x16x32_bf16 v[56:59], v[156:159], a[128:131], v[136:139]
ds_read_b64_tr_b16 v[192:193], v8 offset:49152
v_exp_f32 v34, v81
v_mfma_f32_16x16x32_bf16 v[60:63], v[156:159], a[144:147], v[140:143]
ds_read_b64_tr_b16 v[194:195], v8 offset:53248
v_add_f32 v24, v33, v34
v_cvt_pk_bf16_f32 v128, v33, v34
v_mfma_f32_16x16x32_bf16 v[64:67], v[156:159], a[160:163], v[144:147]
buffer_load_dwordx4 v16, s[20:23], s29 offen lds
v_mfma_f32_16x16x32_bf16 v[68:71], v[156:159], a[176:179], v[148:151]
s_waitcnt lgkmcnt(3)
v_exp_f32 v35, v84
v_mfma_f32_16x16x32_bf16 a[16:19], v[188:191], v[104:107], a[16:19]
ds_read_b128 v[164:167], v3 offset:4096
v_exp_f32 v36, v85
v_mfma_f32_16x16x32_bf16 a[20:23], v[188:191], v[108:111], a[20:23]
buffer_load_dwordx4 v17, s[20:23], s29 offen offset:1024 lds
v_mfma_f32_16x16x32_bf16 a[24:27], v[188:191], v[112:115], a[24:27]
s_add_u32 s29, s29, 8192
v_add_f32 v25, v35, v36
v_cvt_pk_bf16_f32 v132, v35, v36
v_mfma_f32_16x16x32_bf16 a[28:31], v[188:191], v[116:119], a[28:31]
s_waitcnt lgkmcnt(3)
v_exp_f32 v29, v74
v_mfma_f32_16x16x32_bf16 v[40:43], v[160:163], a[132:135], v[40:43]
ds_read_b64_tr_b16 v[196:197], v9 offset:49152
v_exp_f32 v30, v75
v_mfma_f32_16x16x32_bf16 v[44:47], v[160:163], a[148:151], v[44:47]
ds_read_b64_tr_b16 v[198:199], v9 offset:53248
v_add_f32 v22, v22, v29
v_add_f32 v22, v22, v30
v_mfma_f32_16x16x32_bf16 v[48:51], v[160:163], a[164:167], v[48:51]
v_cvt_pk_bf16_f32 v121, v29, v30
v_exp_f32 v31, v78
v_mfma_f32_16x16x32_bf16 v[52:55], v[160:163], a[180:183], v[52:55]
s_waitcnt lgkmcnt(3)
v_exp_f32 v32, v79
v_mfma_f32_16x16x32_bf16 a[32:35], v[192:195], v[104:107], a[32:35]
ds_read_b128 v[168:171], v4 offset:0
v_add_f32 v23, v23, v31
v_add_f32 v23, v23, v32
v_mfma_f32_16x16x32_bf16 a[36:39], v[192:195], v[108:111], a[36:39]
v_cvt_pk_bf16_f32 v125, v31, v32
v_exp_f32 v33, v82
v_mfma_f32_16x16x32_bf16 a[40:43], v[192:195], v[112:115], a[40:43]
v_exp_f32 v34, v83
v_mfma_f32_16x16x32_bf16 a[44:47], v[192:195], v[116:119], a[44:47]
s_waitcnt lgkmcnt(3)
v_add_f32 v24, v24, v33
v_add_f32 v24, v24, v34
v_mfma_f32_16x16x32_bf16 v[56:59], v[164:167], a[132:135], v[56:59]
ds_read_b64_tr_b16 v[200:201], v10 offset:49152
v_cvt_pk_bf16_f32 v129, v33, v34
v_mfma_f32_16x16x32_bf16 v[60:63], v[164:167], a[148:151], v[60:63]
ds_read_b64_tr_b16 v[202:203], v10 offset:53248
v_exp_f32 v35, v86
v_mfma_f32_16x16x32_bf16 v[64:67], v[164:167], a[164:167], v[64:67]
v_exp_f32 v36, v87
v_mfma_f32_16x16x32_bf16 v[68:71], v[164:167], a[180:183], v[68:71]
s_waitcnt lgkmcnt(3)
v_add_f32 v25, v25, v35
v_add_f32 v25, v25, v36
v_mfma_f32_16x16x32_bf16 a[48:51], v[196:199], v[104:107], a[48:51]
ds_read_b128 v[172:175], v4 offset:4096
v_cvt_pk_bf16_f32 v133, v35, v36
v_mfma_f32_16x16x32_bf16 a[52:55], v[196:199], v[108:111], a[52:55]
v_exp_f32 v29, v88
v_mfma_f32_16x16x32_bf16 a[56:59], v[196:199], v[112:115], a[56:59]
v_exp_f32 v30, v89
v_mfma_f32_16x16x32_bf16 a[60:63], v[196:199], v[116:119], a[60:63]
s_waitcnt lgkmcnt(3)
v_add_f32 v22, v22, v29
v_add_f32 v22, v22, v30
v_mfma_f32_16x16x32_bf16 v[40:43], v[168:171], a[136:139], v[40:43]
ds_read_b64_tr_b16 v[204:205], v11 offset:49152
v_cvt_pk_bf16_f32 v122, v29, v30
v_mfma_f32_16x16x32_bf16 v[44:47], v[168:171], a[152:155], v[44:47]
ds_read_b64_tr_b16 v[206:207], v11 offset:53248
v_exp_f32 v31, v92
v_mfma_f32_16x16x32_bf16 v[48:51], v[168:171], a[168:171], v[48:51]
v_exp_f32 v32, v93
v_mfma_f32_16x16x32_bf16 v[52:55], v[168:171], a[184:187], v[52:55]
s_waitcnt lgkmcnt(3)
v_add_f32 v23, v23, v31
v_add_f32 v23, v23, v32
v_mfma_f32_16x16x32_bf16 a[64:67], v[200:203], v[104:107], a[64:67]
ds_read_b128 v[176:179], v5 offset:0
v_cvt_pk_bf16_f32 v126, v31, v32
v_mfma_f32_16x16x32_bf16 a[68:71], v[200:203], v[108:111], a[68:71]
v_exp_f32 v33, v96
v_mfma_f32_16x16x32_bf16 a[72:75], v[200:203], v[112:115], a[72:75]
v_exp_f32 v34, v97
v_mfma_f32_16x16x32_bf16 a[76:79], v[200:203], v[116:119], a[76:79]
s_waitcnt lgkmcnt(3)
v_add_f32 v24, v24, v33
v_add_f32 v24, v24, v34
v_mfma_f32_16x16x32_bf16 v[56:59], v[172:175], a[136:139], v[56:59]
ds_read_b64_tr_b16 v[208:209], v12 offset:49152
v_cvt_pk_bf16_f32 v130, v33, v34
v_mfma_f32_16x16x32_bf16 v[60:63], v[172:175], a[152:155], v[60:63]
ds_read_b64_tr_b16 v[210:211], v12 offset:53248
v_exp_f32 v35, v100
v_mfma_f32_16x16x32_bf16 v[64:67], v[172:175], a[168:171], v[64:67]
v_exp_f32 v36, v101
v_mfma_f32_16x16x32_bf16 v[68:71], v[172:175], a[184:187], v[68:71]
s_waitcnt lgkmcnt(3)
v_add_f32 v25, v25, v35
v_add_f32 v25, v25, v36
v_mfma_f32_16x16x32_bf16 a[80:83], v[204:207], v[104:107], a[80:83]
ds_read_b128 v[180:183], v5 offset:4096
v_cvt_pk_bf16_f32 v134, v35, v36
v_mfma_f32_16x16x32_bf16 a[84:87], v[204:207], v[108:111], a[84:87]
v_exp_f32 v29, v90
v_mfma_f32_16x16x32_bf16 a[88:91], v[204:207], v[112:115], a[88:91]
v_exp_f32 v30, v91
v_mfma_f32_16x16x32_bf16 a[92:95], v[204:207], v[116:119], a[92:95]
s_waitcnt lgkmcnt(3)
v_add_f32 v22, v22, v29
v_add_f32 v22, v22, v30
v_mfma_f32_16x16x32_bf16 v[40:43], v[176:179], a[140:143], v[40:43]
ds_read_b64_tr_b16 v[212:213], v13 offset:49152
v_cvt_pk_bf16_f32 v123, v29, v30
v_mfma_f32_16x16x32_bf16 v[44:47], v[176:179], a[156:159], v[44:47]
ds_read_b64_tr_b16 v[214:215], v13 offset:53248
v_exp_f32 v31, v94
v_mfma_f32_16x16x32_bf16 v[48:51], v[176:179], a[172:175], v[48:51]
v_exp_f32 v32, v95
v_mfma_f32_16x16x32_bf16 v[52:55], v[176:179], a[188:191], v[52:55]
s_waitcnt lgkmcnt(3)
s_waitcnt vmcnt(4)
s_barrier
v_mfma_f32_16x16x32_bf16 a[96:99], v[208:211], v[104:107], a[96:99]
ds_read_b128 v[152:155], v2 offset:8192
v_add_f32 v23, v23, v31
v_add_f32 v23, v23, v32
v_mfma_f32_16x16x32_bf16 a[100:103], v[208:211], v[108:111], a[100:103]
s_add_u32 m0, s30, 24576
v_cvt_pk_bf16_f32 v127, v31, v32
v_mfma_f32_16x16x32_bf16 a[104:107], v[208:211], v[112:115], a[104:107]
buffer_load_dwordx4 v14, s[16:19], s28 offen lds
v_mfma_f32_16x16x32_bf16 a[108:111], v[208:211], v[116:119], a[108:111]
s_waitcnt lgkmcnt(3)
v_exp_f32 v33, v98
v_mfma_f32_16x16x32_bf16 v[56:59], v[180:183], a[140:143], v[56:59]
ds_read_b64_tr_b16 v[184:185], v6 offset:57344
v_exp_f32 v34, v99
v_mfma_f32_16x16x32_bf16 v[60:63], v[180:183], a[156:159], v[60:63]
ds_read_b64_tr_b16 v[186:187], v6 offset:61440
v_add_f32 v24, v24, v33
v_add_f32 v24, v24, v34
v_mfma_f32_16x16x32_bf16 v[64:67], v[180:183], a[172:175], v[64:67]
v_cvt_pk_bf16_f32 v131, v33, v34
v_exp_f32 v35, v102
v_mfma_f32_16x16x32_bf16 v[68:71], v[180:183], a[188:191], v[68:71]
s_waitcnt lgkmcnt(3)
v_exp_f32 v36, v103
v_mfma_f32_16x16x32_bf16 a[112:115], v[212:215], v[104:107], a[112:115]
ds_read_b128 v[156:159], v2 offset:12288
v_add_f32 v25, v25, v35
v_add_f32 v25, v25, v36
v_mfma_f32_16x16x32_bf16 a[116:119], v[212:215], v[108:111], a[116:119]
v_cvt_pk_bf16_f32 v135, v35, v36
v_mfma_f32_16x16x32_bf16 a[120:123], v[212:215], v[112:115], a[120:123]
v_mfma_f32_16x16x32_bf16 a[124:127], v[212:215], v[116:119], a[124:127]
s_waitcnt lgkmcnt(3)
v_max3_f32 v26, v22, v23, v24
v_max_f32 v26, v26, v25
v_cmp_lt_f32 vcc, s32, v26
s_cbranch_vccnz L_RARE_3
L_BACK_3:
v_add_f32 v18, v18, v22
v_add_f32 v19, v19, v23
v_add_f32 v20, v20, v24
v_add_f32 v21, v21, v25
s_sub_u32 s31, s31, 1
s_cmp_lg_u32 s31, 0
s_cbranch_scc1 L_LOOP
ds_read_b64_tr_b16 v[188:189], v7 offset:57344
ds_read_b64_tr_b16 v[190:191], v7 offset:61440
ds_read_b64_tr_b16 v[192:193], v8 offset:57344
ds_read_b64_tr_b16 v[194:195], v8 offset:61440
ds_read_b64_tr_b16 v[196:197], v9 offset:57344
ds_read_b64_tr_b16 v[198:199], v9 offset:61440
ds_read_b64_tr_b16 v[200:201], v10 offset:57344
ds_read_b64_tr_b16 v[202:203], v10 offset:61440
ds_read_b64_tr_b16 v[204:205], v11 offset:57344
ds_read_b64_tr_b16 v[206:207], v11 offset:61440
ds_read_b64_tr_b16 v[208:209], v12 offset:57344
ds_read_b64_tr_b16 v[210:211], v12 offset:61440
ds_read_b64_tr_b16 v[212:213], v13 offset:57344
ds_read_b64_tr_b16 v[214:215], v13 offset:61440
s_waitcnt lgkmcnt(0)
v_mfma_f32_16x16x32_bf16 a[0:3], v[184:187], v[120:123], a[0:3]
v_mfma_f32_16x16x32_bf16 a[4:7], v[184:187], v[124:127], a[4:7]
v_mfma_f32_16x16x32_bf16 a[8:11], v[184:187], v[128:131], a[8:11]
v_mfma_f32_16x16x32_bf16 a[12:15], v[184:187], v[132:135], a[12:15]
v_mfma_f32_16x16x32_bf16 a[16:19], v[188:191], v[120:123], a[16:19]
v_mfma_f32_16x16x32_bf16 a[20:23], v[188:191], v[124:127], a[20:23]
v_mfma_f32_16x16x32_bf16 a[24:27], v[188:191], v[128:131], a[24:27]
v_mfma_f32_16x16x32_bf16 a[28:31], v[188:191], v[132:135], a[28:31]
v_mfma_f32_16x16x32_bf16 a[32:35], v[192:195], v[120:123], a[32:35]
v_mfma_f32_16x16x32_bf16 a[36:39], v[192:195], v[124:127], a[36:39]
v_mfma_f32_16x16x32_bf16 a[40:43], v[192:195], v[128:131], a[40:43]
v_mfma_f32_16x16x32_bf16 a[44:47], v[192:195], v[132:135], a[44:47]
v_mfma_f32_16x16x32_bf16 a[48:51], v[196:199], v[120:123], a[48:51]
v_mfma_f32_16x16x32_bf16 a[52:55], v[196:199], v[124:127], a[52:55]
v_mfma_f32_16x16x32_bf16 a[56:59], v[196:199], v[128:131], a[56:59]
v_mfma_f32_16x16x32_bf16 a[60:63], v[196:199], v[132:135], a[60:63]
v_mfma_f32_16x16x32_bf16 a[64:67], v[200:203], v[120:123], a[64:67]
v_mfma_f32_16x16x32_bf16 a[68:71], v[200:203], v[124:127], a[68:71]
v_mfma_f32_16x16x32_bf16 a[72:75], v[200:203], v[128:131], a[72:75]
v_mfma_f32_16x16x32_bf16 a[76:79], v[200:203], v[132:135], a[76:79]
v_mfma_f32_16x16x32_bf16 a[80:83], v[204:207], v[120:123], a[80:83]
v_mfma_f32_16x16x32_bf16 a[84:87], v[204:207], v[124:127], a[84:87]
v_mfma_f32_16x16x32_bf16 a[88:91], v[204:207], v[128:131], a[88:91]
v_mfma_f32_16x16x32_bf16 a[92:95], v[204:207], v[132:135], a[92:95]
v_mfma_f32_16x16x32_bf16 a[96:99], v[208:211], v[120:123], a[96:99]
v_mfma_f32_16x16x32_bf16 a[100:103], v[208:211], v[124:127], a[100:103]
v_mfma_f32_16x16x32_bf16 a[104:107], v[208:211], v[128:131], a[104:107]
v_mfma_f32_16x16x32_bf16 a[108:111], v[208:211], v[132:135], a[108:111]
v_mfma_f32_16x16x32_bf16 a[112:115], v[212:215], v[120:123], a[112:115]
v_mfma_f32_16x16x32_bf16 a[116:119], v[212:215], v[124:127], a[116:119]
v_mfma_f32_16x16x32_bf16 a[120:123], v[212:215], v[128:131], a[120:123]
v_mfma_f32_16x16x32_bf16 a[124:127], v[212:215], v[132:135], a[124:127]
s_lshl_b32 s34, s12, 11
s_lshl_b32 s35, s13, 8
s_add_u32 s34, s34, s35
s_lshl_b32 s35, s14, 6
s_add_u32 s34, s34, s35
s_lshl_b32 s34, s34, 8
s_add_u32 s24, s10, s34
s_addc_u32 s25, s11, 0
s_mov_b32 s26, 16384
s_mov_b32 s27, 0x00020000
v_and_b32 v26, 15, v1
v_lshrrev_b32 v27, 4, v1
v_and_b32 v39, 2, v27
v_lshlrev_b32 v39, 3, v39
v_and_b32 v29, 1, v27
v_lshl_add_u32 v39, v29, 5, v39
v_lshl_add_u32 v39, v26, 8, v39
s_nop 15
s_nop 15
v_mov_b32 v28, v18
s_nop 1
v_permlane32_swap_b32 v18, v28
s_nop 1
v_add_f32 v18, v18, v28
v_mov_b32 v28, v18
s_nop 1
v_permlane16_swap_b32 v18, v28
s_nop 1
v_add_f32 v18, v18, v28
v_rcp_f32 v26, v18
s_nop 1
v_accvgpr_read_b32 v40, a0
v_accvgpr_read_b32 v41, a1
v_accvgpr_read_b32 v42, a2
v_accvgpr_read_b32 v43, a3
v_accvgpr_read_b32 v44, a16
v_accvgpr_read_b32 v45, a17
v_accvgpr_read_b32 v46, a18
v_accvgpr_read_b32 v47, a19
v_mul_f32 v40, v40, v26
v_mul_f32 v41, v41, v26
v_mul_f32 v42, v42, v26
v_mul_f32 v43, v43, v26
v_mul_f32 v44, v44, v26
v_mul_f32 v45, v45, v26
v_mul_f32 v46, v46, v26
v_mul_f32 v47, v47, v26
v_cvt_pk_bf16_f32 v80, v40, v41
v_cvt_pk_bf16_f32 v81, v42, v43
v_cvt_pk_bf16_f32 v82, v44, v45
v_cvt_pk_bf16_f32 v83, v46, v47
s_nop 1
v_permlane16_swap_b32 v80, v82
v_permlane16_swap_b32 v81, v83
buffer_store_dwordx4 v[80:83], v39, s[24:27], 0 offen offset:0
v_accvgpr_read_b32 v48, a32
v_accvgpr_read_b32 v49, a33
v_accvgpr_read_b32 v50, a34
v_accvgpr_read_b32 v51, a35
v_accvgpr_read_b32 v52, a48
v_accvgpr_read_b32 v53, a49
v_accvgpr_read_b32 v54, a50
v_accvgpr_read_b32 v55, a51
v_mul_f32 v48, v48, v26
v_mul_f32 v49, v49, v26
v_mul_f32 v50, v50, v26
v_mul_f32 v51, v51, v26
v_mul_f32 v52, v52, v26
v_mul_f32 v53, v53, v26
v_mul_f32 v54, v54, v26
v_mul_f32 v55, v55, v26
v_cvt_pk_bf16_f32 v84, v48, v49
v_cvt_pk_bf16_f32 v85, v50, v51
v_cvt_pk_bf16_f32 v86, v52, v53
v_cvt_pk_bf16_f32 v87, v54, v55
s_nop 1
v_permlane16_swap_b32 v84, v86
v_permlane16_swap_b32 v85, v87
buffer_store_dwordx4 v[84:87], v39, s[24:27], 0 offen offset:64
v_accvgpr_read_b32 v56, a64
v_accvgpr_read_b32 v57, a65
v_accvgpr_read_b32 v58, a66
v_accvgpr_read_b32 v59, a67
v_accvgpr_read_b32 v60, a80
v_accvgpr_read_b32 v61, a81
v_accvgpr_read_b32 v62, a82
v_accvgpr_read_b32 v63, a83
v_mul_f32 v56, v56, v26
v_mul_f32 v57, v57, v26
v_mul_f32 v58, v58, v26
v_mul_f32 v59, v59, v26
v_mul_f32 v60, v60, v26
v_mul_f32 v61, v61, v26
v_mul_f32 v62, v62, v26
v_mul_f32 v63, v63, v26
v_cvt_pk_bf16_f32 v88, v56, v57
v_cvt_pk_bf16_f32 v89, v58, v59
v_cvt_pk_bf16_f32 v90, v60, v61
v_cvt_pk_bf16_f32 v91, v62, v63
s_nop 1
v_permlane16_swap_b32 v88, v90
v_permlane16_swap_b32 v89, v91
buffer_store_dwordx4 v[88:91], v39, s[24:27], 0 offen offset:128
v_accvgpr_read_b32 v64, a96
v_accvgpr_read_b32 v65, a97
v_accvgpr_read_b32 v66, a98
v_accvgpr_read_b32 v67, a99
v_accvgpr_read_b32 v68, a112
v_accvgpr_read_b32 v69, a113
v_accvgpr_read_b32 v70, a114
v_accvgpr_read_b32 v71, a115
v_mul_f32 v64, v64, v26
v_mul_f32 v65, v65, v26
v_mul_f32 v66, v66, v26
v_mul_f32 v67, v67, v26
v_mul_f32 v68, v68, v26
v_mul_f32 v69, v69, v26
v_mul_f32 v70, v70, v26
v_mul_f32 v71, v71, v26
v_cvt_pk_bf16_f32 v92, v64, v65
v_cvt_pk_bf16_f32 v93, v66, v67
v_cvt_pk_bf16_f32 v94, v68, v69
v_cvt_pk_bf16_f32 v95, v70, v71
s_nop 1
v_permlane16_swap_b32 v92, v94
v_permlane16_swap_b32 v93, v95
buffer_store_dwordx4 v[92:95], v39, s[24:27], 0 offen offset:192
v_mov_b32 v28, v19
s_nop 1
v_permlane32_swap_b32 v19, v28
s_nop 1
v_add_f32 v19, v19, v28
v_mov_b32 v28, v19
s_nop 1
v_permlane16_swap_b32 v19, v28
s_nop 1
v_add_f32 v19, v19, v28
v_rcp_f32 v26, v19
s_nop 1
v_accvgpr_read_b32 v40, a4
v_accvgpr_read_b32 v41, a5
v_accvgpr_read_b32 v42, a6
v_accvgpr_read_b32 v43, a7
v_accvgpr_read_b32 v44, a20
v_accvgpr_read_b32 v45, a21
v_accvgpr_read_b32 v46, a22
v_accvgpr_read_b32 v47, a23
v_mul_f32 v40, v40, v26
v_mul_f32 v41, v41, v26
v_mul_f32 v42, v42, v26
v_mul_f32 v43, v43, v26
v_mul_f32 v44, v44, v26
v_mul_f32 v45, v45, v26
v_mul_f32 v46, v46, v26
v_mul_f32 v47, v47, v26
v_cvt_pk_bf16_f32 v80, v40, v41
v_cvt_pk_bf16_f32 v81, v42, v43
v_cvt_pk_bf16_f32 v82, v44, v45
v_cvt_pk_bf16_f32 v83, v46, v47
s_nop 1
v_permlane16_swap_b32 v80, v82
v_permlane16_swap_b32 v81, v83
buffer_store_dwordx4 v[80:83], v39, s[24:27], s36 offen offset:0
v_accvgpr_read_b32 v48, a36
v_accvgpr_read_b32 v49, a37
v_accvgpr_read_b32 v50, a38
v_accvgpr_read_b32 v51, a39
v_accvgpr_read_b32 v52, a52
v_accvgpr_read_b32 v53, a53
v_accvgpr_read_b32 v54, a54
v_accvgpr_read_b32 v55, a55
v_mul_f32 v48, v48, v26
v_mul_f32 v49, v49, v26
v_mul_f32 v50, v50, v26
v_mul_f32 v51, v51, v26
v_mul_f32 v52, v52, v26
v_mul_f32 v53, v53, v26
v_mul_f32 v54, v54, v26
v_mul_f32 v55, v55, v26
v_cvt_pk_bf16_f32 v84, v48, v49
v_cvt_pk_bf16_f32 v85, v50, v51
v_cvt_pk_bf16_f32 v86, v52, v53
v_cvt_pk_bf16_f32 v87, v54, v55
s_nop 1
v_permlane16_swap_b32 v84, v86
v_permlane16_swap_b32 v85, v87
buffer_store_dwordx4 v[84:87], v39, s[24:27], s36 offen offset:64
v_accvgpr_read_b32 v56, a68
v_accvgpr_read_b32 v57, a69
v_accvgpr_read_b32 v58, a70
v_accvgpr_read_b32 v59, a71
v_accvgpr_read_b32 v60, a84
v_accvgpr_read_b32 v61, a85
v_accvgpr_read_b32 v62, a86
v_accvgpr_read_b32 v63, a87
v_mul_f32 v56, v56, v26
v_mul_f32 v57, v57, v26
v_mul_f32 v58, v58, v26
v_mul_f32 v59, v59, v26
v_mul_f32 v60, v60, v26
v_mul_f32 v61, v61, v26
v_mul_f32 v62, v62, v26
v_mul_f32 v63, v63, v26
v_cvt_pk_bf16_f32 v88, v56, v57
v_cvt_pk_bf16_f32 v89, v58, v59
v_cvt_pk_bf16_f32 v90, v60, v61
v_cvt_pk_bf16_f32 v91, v62, v63
s_nop 1
v_permlane16_swap_b32 v88, v90
v_permlane16_swap_b32 v89, v91
buffer_store_dwordx4 v[88:91], v39, s[24:27], s36 offen offset:128
v_accvgpr_read_b32 v64, a100
v_accvgpr_read_b32 v65, a101
v_accvgpr_read_b32 v66, a102
v_accvgpr_read_b32 v67, a103
v_accvgpr_read_b32 v68, a116
v_accvgpr_read_b32 v69, a117
v_accvgpr_read_b32 v70, a118
v_accvgpr_read_b32 v71, a119
v_mul_f32 v64, v64, v26
v_mul_f32 v65, v65, v26
v_mul_f32 v66, v66, v26
v_mul_f32 v67, v67, v26
v_mul_f32 v68, v68, v26
v_mul_f32 v69, v69, v26
v_mul_f32 v70, v70, v26
v_mul_f32 v71, v71, v26
v_cvt_pk_bf16_f32 v92, v64, v65
v_cvt_pk_bf16_f32 v93, v66, v67
v_cvt_pk_bf16_f32 v94, v68, v69
v_cvt_pk_bf16_f32 v95, v70, v71
s_nop 1
v_permlane16_swap_b32 v92, v94
v_permlane16_swap_b32 v93, v95
buffer_store_dwordx4 v[92:95], v39, s[24:27], s36 offen offset:192
v_mov_b32 v28, v20
s_nop 1
v_permlane32_swap_b32 v20, v28
s_nop 1
v_add_f32 v20, v20, v28
v_mov_b32 v28, v20
s_nop 1
v_permlane16_swap_b32 v20, v28
s_nop 1
v_add_f32 v20, v20, v28
v_rcp_f32 v26, v20
s_nop 1
v_accvgpr_read_b32 v40, a8
v_accvgpr_read_b32 v41, a9
v_accvgpr_read_b32 v42, a10
v_accvgpr_read_b32 v43, a11
v_accvgpr_read_b32 v44, a24
v_accvgpr_read_b32 v45, a25
v_accvgpr_read_b32 v46, a26
v_accvgpr_read_b32 v47, a27
v_mul_f32 v40, v40, v26
v_mul_f32 v41, v41, v26
v_mul_f32 v42, v42, v26
v_mul_f32 v43, v43, v26
v_mul_f32 v44, v44, v26
v_mul_f32 v45, v45, v26
v_mul_f32 v46, v46, v26
v_mul_f32 v47, v47, v26
v_cvt_pk_bf16_f32 v80, v40, v41
v_cvt_pk_bf16_f32 v81, v42, v43
v_cvt_pk_bf16_f32 v82, v44, v45
v_cvt_pk_bf16_f32 v83, v46, v47
s_nop 1
v_permlane16_swap_b32 v80, v82
v_permlane16_swap_b32 v81, v83
buffer_store_dwordx4 v[80:83], v39, s[24:27], s37 offen offset:0
v_accvgpr_read_b32 v48, a40
v_accvgpr_read_b32 v49, a41
v_accvgpr_read_b32 v50, a42
v_accvgpr_read_b32 v51, a43
v_accvgpr_read_b32 v52, a56
v_accvgpr_read_b32 v53, a57
v_accvgpr_read_b32 v54, a58
v_accvgpr_read_b32 v55, a59
v_mul_f32 v48, v48, v26
v_mul_f32 v49, v49, v26
v_mul_f32 v50, v50, v26
v_mul_f32 v51, v51, v26
v_mul_f32 v52, v52, v26
v_mul_f32 v53, v53, v26
v_mul_f32 v54, v54, v26
v_mul_f32 v55, v55, v26
v_cvt_pk_bf16_f32 v84, v48, v49
v_cvt_pk_bf16_f32 v85, v50, v51
v_cvt_pk_bf16_f32 v86, v52, v53
v_cvt_pk_bf16_f32 v87, v54, v55
s_nop 1
v_permlane16_swap_b32 v84, v86
v_permlane16_swap_b32 v85, v87
buffer_store_dwordx4 v[84:87], v39, s[24:27], s37 offen offset:64
v_accvgpr_read_b32 v56, a72
v_accvgpr_read_b32 v57, a73
v_accvgpr_read_b32 v58, a74
v_accvgpr_read_b32 v59, a75
v_accvgpr_read_b32 v60, a88
v_accvgpr_read_b32 v61, a89
v_accvgpr_read_b32 v62, a90
v_accvgpr_read_b32 v63, a91
v_mul_f32 v56, v56, v26
v_mul_f32 v57, v57, v26
v_mul_f32 v58, v58, v26
v_mul_f32 v59, v59, v26
v_mul_f32 v60, v60, v26
v_mul_f32 v61, v61, v26
v_mul_f32 v62, v62, v26
v_mul_f32 v63, v63, v26
v_cvt_pk_bf16_f32 v88, v56, v57
v_cvt_pk_bf16_f32 v89, v58, v59
v_cvt_pk_bf16_f32 v90, v60, v61
v_cvt_pk_bf16_f32 v91, v62, v63
s_nop 1
v_permlane16_swap_b32 v88, v90
v_permlane16_swap_b32 v89, v91
buffer_store_dwordx4 v[88:91], v39, s[24:27], s37 offen offset:128
v_accvgpr_read_b32 v64, a104
v_accvgpr_read_b32 v65, a105
v_accvgpr_read_b32 v66, a106
v_accvgpr_read_b32 v67, a107
v_accvgpr_read_b32 v68, a120
v_accvgpr_read_b32 v69, a121
v_accvgpr_read_b32 v70, a122
v_accvgpr_read_b32 v71, a123
v_mul_f32 v64, v64, v26
v_mul_f32 v65, v65, v26
v_mul_f32 v66, v66, v26
v_mul_f32 v67, v67, v26
v_mul_f32 v68, v68, v26
v_mul_f32 v69, v69, v26
v_mul_f32 v70, v70, v26
v_mul_f32 v71, v71, v26
v_cvt_pk_bf16_f32 v92, v64, v65
v_cvt_pk_bf16_f32 v93, v66, v67
v_cvt_pk_bf16_f32 v94, v68, v69
v_cvt_pk_bf16_f32 v95, v70, v71
s_nop 1
v_permlane16_swap_b32 v92, v94
v_permlane16_swap_b32 v93, v95
buffer_store_dwordx4 v[92:95], v39, s[24:27], s37 offen offset:192
v_mov_b32 v28, v21
s_nop 1
v_permlane32_swap_b32 v21, v28
s_nop 1
v_add_f32 v21, v21, v28
v_mov_b32 v28, v21
s_nop 1
v_permlane16_swap_b32 v21, v28
s_nop 1
v_add_f32 v21, v21, v28
v_rcp_f32 v26, v21
s_nop 1
v_accvgpr_read_b32 v40, a12
v_accvgpr_read_b32 v41, a13
v_accvgpr_read_b32 v42, a14
v_accvgpr_read_b32 v43, a15
v_accvgpr_read_b32 v44, a28
v_accvgpr_read_b32 v45, a29
v_accvgpr_read_b32 v46, a30
v_accvgpr_read_b32 v47, a31
v_mul_f32 v40, v40, v26
v_mul_f32 v41, v41, v26
v_mul_f32 v42, v42, v26
v_mul_f32 v43, v43, v26
v_mul_f32 v44, v44, v26
v_mul_f32 v45, v45, v26
v_mul_f32 v46, v46, v26
v_mul_f32 v47, v47, v26
v_cvt_pk_bf16_f32 v80, v40, v41
v_cvt_pk_bf16_f32 v81, v42, v43
v_cvt_pk_bf16_f32 v82, v44, v45
v_cvt_pk_bf16_f32 v83, v46, v47
s_nop 1
v_permlane16_swap_b32 v80, v82
v_permlane16_swap_b32 v81, v83
buffer_store_dwordx4 v[80:83], v39, s[24:27], s38 offen offset:0
v_accvgpr_read_b32 v48, a44
v_accvgpr_read_b32 v49, a45
v_accvgpr_read_b32 v50, a46
v_accvgpr_read_b32 v51, a47
v_accvgpr_read_b32 v52, a60
v_accvgpr_read_b32 v53, a61
v_accvgpr_read_b32 v54, a62
v_accvgpr_read_b32 v55, a63
v_mul_f32 v48, v48, v26
v_mul_f32 v49, v49, v26
v_mul_f32 v50, v50, v26
v_mul_f32 v51, v51, v26
v_mul_f32 v52, v52, v26
v_mul_f32 v53, v53, v26
v_mul_f32 v54, v54, v26
v_mul_f32 v55, v55, v26
v_cvt_pk_bf16_f32 v84, v48, v49
v_cvt_pk_bf16_f32 v85, v50, v51
v_cvt_pk_bf16_f32 v86, v52, v53
v_cvt_pk_bf16_f32 v87, v54, v55
s_nop 1
v_permlane16_swap_b32 v84, v86
v_permlane16_swap_b32 v85, v87
buffer_store_dwordx4 v[84:87], v39, s[24:27], s38 offen offset:64
v_accvgpr_read_b32 v56, a76
v_accvgpr_read_b32 v57, a77
v_accvgpr_read_b32 v58, a78
v_accvgpr_read_b32 v59, a79
v_accvgpr_read_b32 v60, a92
v_accvgpr_read_b32 v61, a93
v_accvgpr_read_b32 v62, a94
v_accvgpr_read_b32 v63, a95
v_mul_f32 v56, v56, v26
v_mul_f32 v57, v57, v26
v_mul_f32 v58, v58, v26
v_mul_f32 v59, v59, v26
v_mul_f32 v60, v60, v26
v_mul_f32 v61, v61, v26
v_mul_f32 v62, v62, v26
v_mul_f32 v63, v63, v26
v_cvt_pk_bf16_f32 v88, v56, v57
v_cvt_pk_bf16_f32 v89, v58, v59
v_cvt_pk_bf16_f32 v90, v60, v61
v_cvt_pk_bf16_f32 v91, v62, v63
s_nop 1
v_permlane16_swap_b32 v88, v90
v_permlane16_swap_b32 v89, v91
buffer_store_dwordx4 v[88:91], v39, s[24:27], s38 offen offset:128
v_accvgpr_read_b32 v64, a108
v_accvgpr_read_b32 v65, a109
v_accvgpr_read_b32 v66, a110
v_accvgpr_read_b32 v67, a111
v_accvgpr_read_b32 v68, a124
v_accvgpr_read_b32 v69, a125
v_accvgpr_read_b32 v70, a126
v_accvgpr_read_b32 v71, a127
v_mul_f32 v64, v64, v26
v_mul_f32 v65, v65, v26
v_mul_f32 v66, v66, v26
v_mul_f32 v67, v67, v26
v_mul_f32 v68, v68, v26
v_mul_f32 v69, v69, v26
v_mul_f32 v70, v70, v26
v_mul_f32 v71, v71, v26
v_cvt_pk_bf16_f32 v92, v64, v65
v_cvt_pk_bf16_f32 v93, v66, v67
v_cvt_pk_bf16_f32 v94, v68, v69
v_cvt_pk_bf16_f32 v95, v70, v71
s_nop 1
v_permlane16_swap_b32 v92, v94
v_permlane16_swap_b32 v93, v95
buffer_store_dwordx4 v[92:95], v39, s[24:27], s38 offen offset:192
s_branch L_END
L_RARE_0:
s_nop 15
s_nop 15
v_max3_f32 v31, v40, v41, v42
v_max3_f32 v31, v31, v43, v56
v_max3_f32 v31, v31, v57, v58
v_max_f32 v31, v31, v59
v_mov_b32 v28, v31
s_nop 1
v_permlane32_swap_b32 v31, v28
s_nop 1
v_max_f32 v31, v31, v28
v_mov_b32 v28, v31
s_nop 1
v_permlane16_swap_b32 v31, v28
s_nop 1
v_max_f32 v31, v31, v28
v_max_f32 v31, 0, v31
v_exp_f32_e64 v32, -v31
v_sub_f32 v136, v136, v31
v_sub_f32 v137, v137, v31
v_sub_f32 v138, v138, v31
v_sub_f32 v139, v139, v31
v_sub_f32 v40, v40, v31
v_sub_f32 v72, v72, v31
v_sub_f32 v41, v41, v31
v_sub_f32 v73, v73, v31
v_sub_f32 v42, v42, v31
v_sub_f32 v74, v74, v31
v_sub_f32 v43, v43, v31
v_sub_f32 v75, v75, v31
v_sub_f32 v56, v56, v31
v_sub_f32 v88, v88, v31
v_sub_f32 v57, v57, v31
v_sub_f32 v89, v89, v31
v_sub_f32 v58, v58, v31
v_sub_f32 v90, v90, v31
v_sub_f32 v59, v59, v31
v_sub_f32 v91, v91, v31
v_mul_f32 v18, v18, v32
v_accvgpr_read_b32 v33, a0
s_nop 0
v_mul_f32 v33, v33, v32
v_accvgpr_write_b32 a0, v33
v_accvgpr_read_b32 v33, a1
s_nop 0
v_mul_f32 v33, v33, v32
v_accvgpr_write_b32 a1, v33
v_accvgpr_read_b32 v33, a2
s_nop 0
v_mul_f32 v33, v33, v32
v_accvgpr_write_b32 a2, v33
v_accvgpr_read_b32 v33, a3
s_nop 0
v_mul_f32 v33, v33, v32
v_accvgpr_write_b32 a3, v33
v_accvgpr_read_b32 v33, a16
s_nop 0
v_mul_f32 v33, v33, v32
v_accvgpr_write_b32 a16, v33
v_accvgpr_read_b32 v33, a17
s_nop 0
v_mul_f32 v33, v33, v32
v_accvgpr_write_b32 a17, v33
v_accvgpr_read_b32 v33, a18
s_nop 0
v_mul_f32 v33, v33, v32
v_accvgpr_write_b32 a18, v33
v_accvgpr_read_b32 v33, a19
s_nop 0
v_mul_f32 v33, v33, v32
v_accvgpr_write_b32 a19, v33
v_accvgpr_read_b32 v33, a32
s_nop 0
v_mul_f32 v33, v33, v32
v_accvgpr_write_b32 a32, v33
v_accvgpr_read_b32 v33, a33
s_nop 0
v_mul_f32 v33, v33, v32
v_accvgpr_write_b32 a33, v33
v_accvgpr_read_b32 v33, a34
s_nop 0
v_mul_f32 v33, v33, v32
v_accvgpr_write_b32 a34, v33
v_accvgpr_read_b32 v33, a35
s_nop 0
v_mul_f32 v33, v33, v32
v_accvgpr_write_b32 a35, v33
v_accvgpr_read_b32 v33, a48
s_nop 0
v_mul_f32 v33, v33, v32
v_accvgpr_write_b32 a48, v33
v_accvgpr_read_b32 v33, a49
s_nop 0
v_mul_f32 v33, v33, v32
v_accvgpr_write_b32 a49, v33
v_accvgpr_read_b32 v33, a50
s_nop 0
v_mul_f32 v33, v33, v32
v_accvgpr_write_b32 a50, v33
v_accvgpr_read_b32 v33, a51
s_nop 0
v_mul_f32 v33, v33, v32
v_accvgpr_write_b32 a51, v33
v_accvgpr_read_b32 v33, a64
s_nop 0
v_mul_f32 v33, v33, v32
v_accvgpr_write_b32 a64, v33
v_accvgpr_read_b32 v33, a65
s_nop 0
v_mul_f32 v33, v33, v32
v_accvgpr_write_b32 a65, v33
v_accvgpr_read_b32 v33, a66
s_nop 0
v_mul_f32 v33, v33, v32
v_accvgpr_write_b32 a66, v33
v_accvgpr_read_b32 v33, a67
s_nop 0
v_mul_f32 v33, v33, v32
v_accvgpr_write_b32 a67, v33
v_accvgpr_read_b32 v33, a80
s_nop 0
v_mul_f32 v33, v33, v32
v_accvgpr_write_b32 a80, v33
v_accvgpr_read_b32 v33, a81
s_nop 0
v_mul_f32 v33, v33, v32
v_accvgpr_write_b32 a81, v33
v_accvgpr_read_b32 v33, a82
s_nop 0
v_mul_f32 v33, v33, v32
v_accvgpr_write_b32 a82, v33
v_accvgpr_read_b32 v33, a83
s_nop 0
v_mul_f32 v33, v33, v32
v_accvgpr_write_b32 a83, v33
v_accvgpr_read_b32 v33, a96
s_nop 0
v_mul_f32 v33, v33, v32
v_accvgpr_write_b32 a96, v33
v_accvgpr_read_b32 v33, a97
s_nop 0
v_mul_f32 v33, v33, v32
v_accvgpr_write_b32 a97, v33
v_accvgpr_read_b32 v33, a98
s_nop 0
v_mul_f32 v33, v33, v32
v_accvgpr_write_b32 a98, v33
v_accvgpr_read_b32 v33, a99
s_nop 0
v_mul_f32 v33, v33, v32
v_accvgpr_write_b32 a99, v33
v_accvgpr_read_b32 v33, a112
s_nop 0
v_mul_f32 v33, v33, v32
v_accvgpr_write_b32 a112, v33
v_accvgpr_read_b32 v33, a113
s_nop 0
v_mul_f32 v33, v33, v32
v_accvgpr_write_b32 a113, v33
v_accvgpr_read_b32 v33, a114
s_nop 0
v_mul_f32 v33, v33, v32
v_accvgpr_write_b32 a114, v33
v_accvgpr_read_b32 v33, a115
s_nop 0
v_mul_f32 v33, v33, v32
v_accvgpr_write_b32 a115, v33
v_max3_f32 v31, v44, v45, v46
v_max3_f32 v31, v31, v47, v60
v_max3_f32 v31, v31, v61, v62
v_max_f32 v31, v31, v63
v_mov_b32 v28, v31
s_nop 1
v_permlane32_swap_b32 v31, v28
s_nop 1
v_max_f32 v31, v31, v28
v_mov_b32 v28, v31
s_nop 1
v_permlane16_swap_b32 v31, v28
s_nop 1
v_max_f32 v31, v31, v28
v_max_f32 v31, 0, v31
v_exp_f32_e64 v32, -v31
v_sub_f32 v140, v140, v31
v_sub_f32 v141, v141, v31
v_sub_f32 v142, v142, v31
v_sub_f32 v143, v143, v31
v_sub_f32 v44, v44, v31
v_sub_f32 v76, v76, v31
v_sub_f32 v45, v45, v31
v_sub_f32 v77, v77, v31
v_sub_f32 v46, v46, v31
v_sub_f32 v78, v78, v31
v_sub_f32 v47, v47, v31
v_sub_f32 v79, v79, v31
v_sub_f32 v60, v60, v31
v_sub_f32 v92, v92, v31
v_sub_f32 v61, v61, v31
v_sub_f32 v93, v93, v31
v_sub_f32 v62, v62, v31
v_sub_f32 v94, v94, v31
v_sub_f32 v63, v63, v31
v_sub_f32 v95, v95, v31
v_mul_f32 v19, v19, v32
v_accvgpr_read_b32 v33, a4
s_nop 0
v_mul_f32 v33, v33, v32
v_accvgpr_write_b32 a4, v33
v_accvgpr_read_b32 v33, a5
s_nop 0
v_mul_f32 v33, v33, v32
v_accvgpr_write_b32 a5, v33
v_accvgpr_read_b32 v33, a6
s_nop 0
v_mul_f32 v33, v33, v32
v_accvgpr_write_b32 a6, v33
v_accvgpr_read_b32 v33, a7
s_nop 0
v_mul_f32 v33, v33, v32
v_accvgpr_write_b32 a7, v33
v_accvgpr_read_b32 v33, a20
s_nop 0
v_mul_f32 v33, v33, v32
v_accvgpr_write_b32 a20, v33
v_accvgpr_read_b32 v33, a21
s_nop 0
v_mul_f32 v33, v33, v32
v_accvgpr_write_b32 a21, v33
v_accvgpr_read_b32 v33, a22
s_nop 0
v_mul_f32 v33, v33, v32
v_accvgpr_write_b32 a22, v33
v_accvgpr_read_b32 v33, a23
s_nop 0
v_mul_f32 v33, v33, v32
v_accvgpr_write_b32 a23, v33
v_accvgpr_read_b32 v33, a36
s_nop 0
v_mul_f32 v33, v33, v32
v_accvgpr_write_b32 a36, v33
v_accvgpr_read_b32 v33, a37
s_nop 0
v_mul_f32 v33, v33, v32
v_accvgpr_write_b32 a37, v33
v_accvgpr_read_b32 v33, a38
s_nop 0
v_mul_f32 v33, v33, v32
v_accvgpr_write_b32 a38, v33
v_accvgpr_read_b32 v33, a39
s_nop 0
v_mul_f32 v33, v33, v32
v_accvgpr_write_b32 a39, v33
v_accvgpr_read_b32 v33, a52
s_nop 0
v_mul_f32 v33, v33, v32
v_accvgpr_write_b32 a52, v33
v_accvgpr_read_b32 v33, a53
s_nop 0
v_mul_f32 v33, v33, v32
v_accvgpr_write_b32 a53, v33
v_accvgpr_read_b32 v33, a54
s_nop 0
v_mul_f32 v33, v33, v32
v_accvgpr_write_b32 a54, v33
v_accvgpr_read_b32 v33, a55
s_nop 0
v_mul_f32 v33, v33, v32
v_accvgpr_write_b32 a55, v33
v_accvgpr_read_b32 v33, a68
s_nop 0
v_mul_f32 v33, v33, v32
v_accvgpr_write_b32 a68, v33
v_accvgpr_read_b32 v33, a69
s_nop 0
v_mul_f32 v33, v33, v32
v_accvgpr_write_b32 a69, v33
v_accvgpr_read_b32 v33, a70
s_nop 0
v_mul_f32 v33, v33, v32
v_accvgpr_write_b32 a70, v33
v_accvgpr_read_b32 v33, a71
s_nop 0
v_mul_f32 v33, v33, v32
v_accvgpr_write_b32 a71, v33
v_accvgpr_read_b32 v33, a84
s_nop 0
v_mul_f32 v33, v33, v32
v_accvgpr_write_b32 a84, v33
v_accvgpr_read_b32 v33, a85
s_nop 0
v_mul_f32 v33, v33, v32
v_accvgpr_write_b32 a85, v33
v_accvgpr_read_b32 v33, a86
s_nop 0
v_mul_f32 v33, v33, v32
v_accvgpr_write_b32 a86, v33
v_accvgpr_read_b32 v33, a87
s_nop 0
v_mul_f32 v33, v33, v32
v_accvgpr_write_b32 a87, v33
v_accvgpr_read_b32 v33, a100
s_nop 0
v_mul_f32 v33, v33, v32
v_accvgpr_write_b32 a100, v33
v_accvgpr_read_b32 v33, a101
s_nop 0
v_mul_f32 v33, v33, v32
v_accvgpr_write_b32 a101, v33
v_accvgpr_read_b32 v33, a102
s_nop 0
v_mul_f32 v33, v33, v32
v_accvgpr_write_b32 a102, v33
v_accvgpr_read_b32 v33, a103
s_nop 0
v_mul_f32 v33, v33, v32
v_accvgpr_write_b32 a103, v33
v_accvgpr_read_b32 v33, a116
s_nop 0
v_mul_f32 v33, v33, v32
v_accvgpr_write_b32 a116, v33
v_accvgpr_read_b32 v33, a117
s_nop 0
v_mul_f32 v33, v33, v32
v_accvgpr_write_b32 a117, v33
v_accvgpr_read_b32 v33, a118
s_nop 0
v_mul_f32 v33, v33, v32
v_accvgpr_write_b32 a118, v33
v_accvgpr_read_b32 v33, a119
s_nop 0
v_mul_f32 v33, v33, v32
v_accvgpr_write_b32 a119, v33
v_max3_f32 v31, v48, v49, v50
v_max3_f32 v31, v31, v51, v64
v_max3_f32 v31, v31, v65, v66
v_max_f32 v31, v31, v67
v_mov_b32 v28, v31
s_nop 1
v_permlane32_swap_b32 v31, v28
s_nop 1
v_max_f32 v31, v31, v28
v_mov_b32 v28, v31
s_nop 1
v_permlane16_swap_b32 v31, v28
s_nop 1
v_max_f32 v31, v31, v28
v_max_f32 v31, 0, v31
v_exp_f32_e64 v32, -v31
v_sub_f32 v144, v144, v31
v_sub_f32 v145, v145, v31
v_sub_f32 v146, v146, v31
v_sub_f32 v147, v147, v31
v_sub_f32 v48, v48, v31
v_sub_f32 v80, v80, v31
v_sub_f32 v49, v49, v31
v_sub_f32 v81, v81, v31
v_sub_f32 v50, v50, v31
v_sub_f32 v82, v82, v31
v_sub_f32 v51, v51, v31
v_sub_f32 v83, v83, v31
v_sub_f32 v64, v64, v31
v_sub_f32 v96, v96, v31
v_sub_f32 v65, v65, v31
v_sub_f32 v97, v97, v31
v_sub_f32 v66, v66, v31
v_sub_f32 v98, v98, v31
v_sub_f32 v67, v67, v31
v_sub_f32 v99, v99, v31
v_mul_f32 v20, v20, v32
v_accvgpr_read_b32 v33, a8
s_nop 0
v_mul_f32 v33, v33, v32
v_accvgpr_write_b32 a8, v33
v_accvgpr_read_b32 v33, a9
s_nop 0
v_mul_f32 v33, v33, v32
v_accvgpr_write_b32 a9, v33
v_accvgpr_read_b32 v33, a10
s_nop 0
v_mul_f32 v33, v33, v32
v_accvgpr_write_b32 a10, v33
v_accvgpr_read_b32 v33, a11
s_nop 0
v_mul_f32 v33, v33, v32
v_accvgpr_write_b32 a11, v33
v_accvgpr_read_b32 v33, a24
s_nop 0
v_mul_f32 v33, v33, v32
v_accvgpr_write_b32 a24, v33
v_accvgpr_read_b32 v33, a25
s_nop 0
v_mul_f32 v33, v33, v32
v_accvgpr_write_b32 a25, v33
v_accvgpr_read_b32 v33, a26
s_nop 0
v_mul_f32 v33, v33, v32
v_accvgpr_write_b32 a26, v33
v_accvgpr_read_b32 v33, a27
s_nop 0
v_mul_f32 v33, v33, v32
v_accvgpr_write_b32 a27, v33
v_accvgpr_read_b32 v33, a40
s_nop 0
v_mul_f32 v33, v33, v32
v_accvgpr_write_b32 a40, v33
v_accvgpr_read_b32 v33, a41
s_nop 0
v_mul_f32 v33, v33, v32
v_accvgpr_write_b32 a41, v33
v_accvgpr_read_b32 v33, a42
s_nop 0
v_mul_f32 v33, v33, v32
v_accvgpr_write_b32 a42, v33
v_accvgpr_read_b32 v33, a43
s_nop 0
v_mul_f32 v33, v33, v32
v_accvgpr_write_b32 a43, v33
v_accvgpr_read_b32 v33, a56
s_nop 0
v_mul_f32 v33, v33, v32
v_accvgpr_write_b32 a56, v33
v_accvgpr_read_b32 v33, a57
s_nop 0
v_mul_f32 v33, v33, v32
v_accvgpr_write_b32 a57, v33
v_accvgpr_read_b32 v33, a58
s_nop 0
v_mul_f32 v33, v33, v32
v_accvgpr_write_b32 a58, v33
v_accvgpr_read_b32 v33, a59
s_nop 0
v_mul_f32 v33, v33, v32
v_accvgpr_write_b32 a59, v33
v_accvgpr_read_b32 v33, a72
s_nop 0
v_mul_f32 v33, v33, v32
v_accvgpr_write_b32 a72, v33
v_accvgpr_read_b32 v33, a73
s_nop 0
v_mul_f32 v33, v33, v32
v_accvgpr_write_b32 a73, v33
v_accvgpr_read_b32 v33, a74
s_nop 0
v_mul_f32 v33, v33, v32
v_accvgpr_write_b32 a74, v33
v_accvgpr_read_b32 v33, a75
s_nop 0
v_mul_f32 v33, v33, v32
v_accvgpr_write_b32 a75, v33
v_accvgpr_read_b32 v33, a88
s_nop 0
v_mul_f32 v33, v33, v32
v_accvgpr_write_b32 a88, v33
v_accvgpr_read_b32 v33, a89
s_nop 0
v_mul_f32 v33, v33, v32
v_accvgpr_write_b32 a89, v33
v_accvgpr_read_b32 v33, a90
s_nop 0
v_mul_f32 v33, v33, v32
v_accvgpr_write_b32 a90, v33
v_accvgpr_read_b32 v33, a91
s_nop 0
v_mul_f32 v33, v33, v32
v_accvgpr_write_b32 a91, v33
v_accvgpr_read_b32 v33, a104
s_nop 0
v_mul_f32 v33, v33, v32
v_accvgpr_write_b32 a104, v33
v_accvgpr_read_b32 v33, a105
s_nop 0
v_mul_f32 v33, v33, v32
v_accvgpr_write_b32 a105, v33
v_accvgpr_read_b32 v33, a106
s_nop 0
v_mul_f32 v33, v33, v32
v_accvgpr_write_b32 a106, v33
v_accvgpr_read_b32 v33, a107
s_nop 0
v_mul_f32 v33, v33, v32
v_accvgpr_write_b32 a107, v33
v_accvgpr_read_b32 v33, a120
s_nop 0
v_mul_f32 v33, v33, v32
v_accvgpr_write_b32 a120, v33
v_accvgpr_read_b32 v33, a121
s_nop 0
v_mul_f32 v33, v33, v32
v_accvgpr_write_b32 a121, v33
v_accvgpr_read_b32 v33, a122
s_nop 0
v_mul_f32 v33, v33, v32
v_accvgpr_write_b32 a122, v33
v_accvgpr_read_b32 v33, a123
s_nop 0
v_mul_f32 v33, v33, v32
v_accvgpr_write_b32 a123, v33
v_max3_f32 v31, v52, v53, v54
v_max3_f32 v31, v31, v55, v68
v_max3_f32 v31, v31, v69, v70
v_max_f32 v31, v31, v71
v_mov_b32 v28, v31
s_nop 1
v_permlane32_swap_b32 v31, v28
s_nop 1
v_max_f32 v31, v31, v28
v_mov_b32 v28, v31
s_nop 1
v_permlane16_swap_b32 v31, v28
s_nop 1
v_max_f32 v31, v31, v28
v_max_f32 v31, 0, v31
v_exp_f32_e64 v32, -v31
v_sub_f32 v148, v148, v31
v_sub_f32 v149, v149, v31
v_sub_f32 v150, v150, v31
v_sub_f32 v151, v151, v31
v_sub_f32 v52, v52, v31
v_sub_f32 v84, v84, v31
v_sub_f32 v53, v53, v31
v_sub_f32 v85, v85, v31
v_sub_f32 v54, v54, v31
v_sub_f32 v86, v86, v31
v_sub_f32 v55, v55, v31
v_sub_f32 v87, v87, v31
v_sub_f32 v68, v68, v31
v_sub_f32 v100, v100, v31
v_sub_f32 v69, v69, v31
v_sub_f32 v101, v101, v31
v_sub_f32 v70, v70, v31
v_sub_f32 v102, v102, v31
v_sub_f32 v71, v71, v31
v_sub_f32 v103, v103, v31
v_mul_f32 v21, v21, v32
v_accvgpr_read_b32 v33, a12
s_nop 0
v_mul_f32 v33, v33, v32
v_accvgpr_write_b32 a12, v33
v_accvgpr_read_b32 v33, a13
s_nop 0
v_mul_f32 v33, v33, v32
v_accvgpr_write_b32 a13, v33
v_accvgpr_read_b32 v33, a14
s_nop 0
v_mul_f32 v33, v33, v32
v_accvgpr_write_b32 a14, v33
v_accvgpr_read_b32 v33, a15
s_nop 0
v_mul_f32 v33, v33, v32
v_accvgpr_write_b32 a15, v33
v_accvgpr_read_b32 v33, a28
s_nop 0
v_mul_f32 v33, v33, v32
v_accvgpr_write_b32 a28, v33
v_accvgpr_read_b32 v33, a29
s_nop 0
v_mul_f32 v33, v33, v32
v_accvgpr_write_b32 a29, v33
v_accvgpr_read_b32 v33, a30
s_nop 0
v_mul_f32 v33, v33, v32
v_accvgpr_write_b32 a30, v33
v_accvgpr_read_b32 v33, a31
s_nop 0
v_mul_f32 v33, v33, v32
v_accvgpr_write_b32 a31, v33
v_accvgpr_read_b32 v33, a44
s_nop 0
v_mul_f32 v33, v33, v32
v_accvgpr_write_b32 a44, v33
v_accvgpr_read_b32 v33, a45
s_nop 0
v_mul_f32 v33, v33, v32
v_accvgpr_write_b32 a45, v33
v_accvgpr_read_b32 v33, a46
s_nop 0
v_mul_f32 v33, v33, v32
v_accvgpr_write_b32 a46, v33
v_accvgpr_read_b32 v33, a47
s_nop 0
v_mul_f32 v33, v33, v32
v_accvgpr_write_b32 a47, v33
v_accvgpr_read_b32 v33, a60
s_nop 0
v_mul_f32 v33, v33, v32
v_accvgpr_write_b32 a60, v33
v_accvgpr_read_b32 v33, a61
s_nop 0
v_mul_f32 v33, v33, v32
v_accvgpr_write_b32 a61, v33
v_accvgpr_read_b32 v33, a62
s_nop 0
v_mul_f32 v33, v33, v32
v_accvgpr_write_b32 a62, v33
v_accvgpr_read_b32 v33, a63
s_nop 0
v_mul_f32 v33, v33, v32
v_accvgpr_write_b32 a63, v33
v_accvgpr_read_b32 v33, a76
s_nop 0
v_mul_f32 v33, v33, v32
v_accvgpr_write_b32 a76, v33
v_accvgpr_read_b32 v33, a77
s_nop 0
v_mul_f32 v33, v33, v32
v_accvgpr_write_b32 a77, v33
v_accvgpr_read_b32 v33, a78
s_nop 0
v_mul_f32 v33, v33, v32
v_accvgpr_write_b32 a78, v33
v_accvgpr_read_b32 v33, a79
s_nop 0
v_mul_f32 v33, v33, v32
v_accvgpr_write_b32 a79, v33
v_accvgpr_read_b32 v33, a92
s_nop 0
v_mul_f32 v33, v33, v32
v_accvgpr_write_b32 a92, v33
v_accvgpr_read_b32 v33, a93
s_nop 0
v_mul_f32 v33, v33, v32
v_accvgpr_write_b32 a93, v33
v_accvgpr_read_b32 v33, a94
s_nop 0
v_mul_f32 v33, v33, v32
v_accvgpr_write_b32 a94, v33
v_accvgpr_read_b32 v33, a95
s_nop 0
v_mul_f32 v33, v33, v32
v_accvgpr_write_b32 a95, v33
v_accvgpr_read_b32 v33, a108
s_nop 0
v_mul_f32 v33, v33, v32
v_accvgpr_write_b32 a108, v33
v_accvgpr_read_b32 v33, a109
s_nop 0
v_mul_f32 v33, v33, v32
v_accvgpr_write_b32 a109, v33
v_accvgpr_read_b32 v33, a110
s_nop 0
v_mul_f32 v33, v33, v32
v_accvgpr_write_b32 a110, v33
v_accvgpr_read_b32 v33, a111
s_nop 0
v_mul_f32 v33, v33, v32
v_accvgpr_write_b32 a111, v33
v_accvgpr_read_b32 v33, a124
s_nop 0
v_mul_f32 v33, v33, v32
v_accvgpr_write_b32 a124, v33
v_accvgpr_read_b32 v33, a125
s_nop 0
v_mul_f32 v33, v33, v32
v_accvgpr_write_b32 a125, v33
v_accvgpr_read_b32 v33, a126
s_nop 0
v_mul_f32 v33, v33, v32
v_accvgpr_write_b32 a126, v33
v_accvgpr_read_b32 v33, a127
s_nop 0
v_mul_f32 v33, v33, v32
v_accvgpr_write_b32 a127, v33
v_exp_f32 v29, v40
v_exp_f32 v30, v41
s_nop 0
v_add_f32 v22, v29, v30
v_cvt_pk_bf16_f32 v104, v29, v30
v_exp_f32 v29, v42
v_exp_f32 v30, v43
s_nop 0
v_add_f32 v22, v22, v29
v_add_f32 v22, v22, v30
v_cvt_pk_bf16_f32 v105, v29, v30
v_exp_f32 v29, v56
v_exp_f32 v30, v57
s_nop 0
v_add_f32 v22, v22, v29
v_add_f32 v22, v22, v30
v_cvt_pk_bf16_f32 v106, v29, v30
v_exp_f32 v29, v58
v_exp_f32 v30, v59
s_nop 0
v_add_f32 v22, v22, v29
v_add_f32 v22, v22, v30
v_cvt_pk_bf16_f32 v107, v29, v30
v_exp_f32 v29, v44
v_exp_f32 v30, v45
s_nop 0
v_add_f32 v23, v29, v30
v_cvt_pk_bf16_f32 v108, v29, v30
v_exp_f32 v29, v46
v_exp_f32 v30, v47
s_nop 0
v_add_f32 v23, v23, v29
v_add_f32 v23, v23, v30
v_cvt_pk_bf16_f32 v109, v29, v30
v_exp_f32 v29, v60
v_exp_f32 v30, v61
s_nop 0
v_add_f32 v23, v23, v29
v_add_f32 v23, v23, v30
v_cvt_pk_bf16_f32 v110, v29, v30
v_exp_f32 v29, v62
v_exp_f32 v30, v63
s_nop 0
v_add_f32 v23, v23, v29
v_add_f32 v23, v23, v30
v_cvt_pk_bf16_f32 v111, v29, v30
v_exp_f32 v29, v48
v_exp_f32 v30, v49
s_nop 0
v_add_f32 v24, v29, v30
v_cvt_pk_bf16_f32 v112, v29, v30
v_exp_f32 v29, v50
v_exp_f32 v30, v51
s_nop 0
v_add_f32 v24, v24, v29
v_add_f32 v24, v24, v30
v_cvt_pk_bf16_f32 v113, v29, v30
v_exp_f32 v29, v64
v_exp_f32 v30, v65
s_nop 0
v_add_f32 v24, v24, v29
v_add_f32 v24, v24, v30
v_cvt_pk_bf16_f32 v114, v29, v30
v_exp_f32 v29, v66
v_exp_f32 v30, v67
s_nop 0
v_add_f32 v24, v24, v29
v_add_f32 v24, v24, v30
v_cvt_pk_bf16_f32 v115, v29, v30
v_exp_f32 v29, v52
v_exp_f32 v30, v53
s_nop 0
v_add_f32 v25, v29, v30
v_cvt_pk_bf16_f32 v116, v29, v30
v_exp_f32 v29, v54
v_exp_f32 v30, v55
s_nop 0
v_add_f32 v25, v25, v29
v_add_f32 v25, v25, v30
v_cvt_pk_bf16_f32 v117, v29, v30
v_exp_f32 v29, v68
v_exp_f32 v30, v69
s_nop 0
v_add_f32 v25, v25, v29
v_add_f32 v25, v25, v30
v_cvt_pk_bf16_f32 v118, v29, v30
v_exp_f32 v29, v70
v_exp_f32 v30, v71
s_nop 0
v_add_f32 v25, v25, v29
v_add_f32 v25, v25, v30
v_cvt_pk_bf16_f32 v119, v29, v30
s_nop 4
s_branch L_BACK_0
L_RARE_1:
s_nop 15
s_nop 15
v_max3_f32 v31, v72, v73, v74
v_max3_f32 v31, v31, v75, v88
v_max3_f32 v31, v31, v89, v90
v_max_f32 v31, v31, v91
v_mov_b32 v28, v31
s_nop 1
v_permlane32_swap_b32 v31, v28
s_nop 1
v_max_f32 v31, v31, v28
v_mov_b32 v28, v31
s_nop 1
v_permlane16_swap_b32 v31, v28
s_nop 1
v_max_f32 v31, v31, v28
v_max_f32 v31, 0, v31
v_exp_f32_e64 v32, -v31
v_sub_f32 v136, v136, v31
v_sub_f32 v137, v137, v31
v_sub_f32 v138, v138, v31
v_sub_f32 v139, v139, v31
v_sub_f32 v72, v72, v31
v_sub_f32 v40, v40, v31
v_sub_f32 v73, v73, v31
v_sub_f32 v41, v41, v31
v_sub_f32 v74, v74, v31
v_sub_f32 v42, v42, v31
v_sub_f32 v75, v75, v31
v_sub_f32 v43, v43, v31
v_sub_f32 v88, v88, v31
v_sub_f32 v56, v56, v31
v_sub_f32 v89, v89, v31
v_sub_f32 v57, v57, v31
v_sub_f32 v90, v90, v31
v_sub_f32 v58, v58, v31
v_sub_f32 v91, v91, v31
v_sub_f32 v59, v59, v31
v_mul_f32 v18, v18, v32
v_accvgpr_read_b32 v33, a0
s_nop 0
v_mul_f32 v33, v33, v32
v_accvgpr_write_b32 a0, v33
v_accvgpr_read_b32 v33, a1
s_nop 0
v_mul_f32 v33, v33, v32
v_accvgpr_write_b32 a1, v33
v_accvgpr_read_b32 v33, a2
s_nop 0
v_mul_f32 v33, v33, v32
v_accvgpr_write_b32 a2, v33
v_accvgpr_read_b32 v33, a3
s_nop 0
v_mul_f32 v33, v33, v32
v_accvgpr_write_b32 a3, v33
v_accvgpr_read_b32 v33, a16
s_nop 0
v_mul_f32 v33, v33, v32
v_accvgpr_write_b32 a16, v33
v_accvgpr_read_b32 v33, a17
s_nop 0
v_mul_f32 v33, v33, v32
v_accvgpr_write_b32 a17, v33
v_accvgpr_read_b32 v33, a18
s_nop 0
v_mul_f32 v33, v33, v32
v_accvgpr_write_b32 a18, v33
v_accvgpr_read_b32 v33, a19
s_nop 0
v_mul_f32 v33, v33, v32
v_accvgpr_write_b32 a19, v33
v_accvgpr_read_b32 v33, a32
s_nop 0
v_mul_f32 v33, v33, v32
v_accvgpr_write_b32 a32, v33
v_accvgpr_read_b32 v33, a33
s_nop 0
v_mul_f32 v33, v33, v32
v_accvgpr_write_b32 a33, v33
v_accvgpr_read_b32 v33, a34
s_nop 0
v_mul_f32 v33, v33, v32
v_accvgpr_write_b32 a34, v33
v_accvgpr_read_b32 v33, a35
s_nop 0
v_mul_f32 v33, v33, v32
v_accvgpr_write_b32 a35, v33
v_accvgpr_read_b32 v33, a48
s_nop 0
v_mul_f32 v33, v33, v32
v_accvgpr_write_b32 a48, v33
v_accvgpr_read_b32 v33, a49
s_nop 0
v_mul_f32 v33, v33, v32
v_accvgpr_write_b32 a49, v33
v_accvgpr_read_b32 v33, a50
s_nop 0
v_mul_f32 v33, v33, v32
v_accvgpr_write_b32 a50, v33
v_accvgpr_read_b32 v33, a51
s_nop 0
v_mul_f32 v33, v33, v32
v_accvgpr_write_b32 a51, v33
v_accvgpr_read_b32 v33, a64
s_nop 0
v_mul_f32 v33, v33, v32
v_accvgpr_write_b32 a64, v33
v_accvgpr_read_b32 v33, a65
s_nop 0
v_mul_f32 v33, v33, v32
v_accvgpr_write_b32 a65, v33
v_accvgpr_read_b32 v33, a66
s_nop 0
v_mul_f32 v33, v33, v32
v_accvgpr_write_b32 a66, v33
v_accvgpr_read_b32 v33, a67
s_nop 0
v_mul_f32 v33, v33, v32
v_accvgpr_write_b32 a67, v33
v_accvgpr_read_b32 v33, a80
s_nop 0
v_mul_f32 v33, v33, v32
v_accvgpr_write_b32 a80, v33
v_accvgpr_read_b32 v33, a81
s_nop 0
v_mul_f32 v33, v33, v32
v_accvgpr_write_b32 a81, v33
v_accvgpr_read_b32 v33, a82
s_nop 0
v_mul_f32 v33, v33, v32
v_accvgpr_write_b32 a82, v33
v_accvgpr_read_b32 v33, a83
s_nop 0
v_mul_f32 v33, v33, v32
v_accvgpr_write_b32 a83, v33
v_accvgpr_read_b32 v33, a96
s_nop 0
v_mul_f32 v33, v33, v32
v_accvgpr_write_b32 a96, v33
v_accvgpr_read_b32 v33, a97
s_nop 0
v_mul_f32 v33, v33, v32
v_accvgpr_write_b32 a97, v33
v_accvgpr_read_b32 v33, a98
s_nop 0
v_mul_f32 v33, v33, v32
v_accvgpr_write_b32 a98, v33
v_accvgpr_read_b32 v33, a99
s_nop 0
v_mul_f32 v33, v33, v32
v_accvgpr_write_b32 a99, v33
v_accvgpr_read_b32 v33, a112
s_nop 0
v_mul_f32 v33, v33, v32
v_accvgpr_write_b32 a112, v33
v_accvgpr_read_b32 v33, a113
s_nop 0
v_mul_f32 v33, v33, v32
v_accvgpr_write_b32 a113, v33
v_accvgpr_read_b32 v33, a114
s_nop 0
v_mul_f32 v33, v33, v32
v_accvgpr_write_b32 a114, v33
v_accvgpr_read_b32 v33, a115
s_nop 0
v_mul_f32 v33, v33, v32
v_accvgpr_write_b32 a115, v33
v_max3_f32 v31, v76, v77, v78
v_max3_f32 v31, v31, v79, v92
v_max3_f32 v31, v31, v93, v94
v_max_f32 v31, v31, v95
v_mov_b32 v28, v31
s_nop 1
v_permlane32_swap_b32 v31, v28
s_nop 1
v_max_f32 v31, v31, v28
v_mov_b32 v28, v31
s_nop 1
v_permlane16_swap_b32 v31, v28
s_nop 1
v_max_f32 v31, v31, v28
v_max_f32 v31, 0, v31
v_exp_f32_e64 v32, -v31
v_sub_f32 v140, v140, v31
v_sub_f32 v141, v141, v31
v_sub_f32 v142, v142, v31
v_sub_f32 v143, v143, v31
v_sub_f32 v76, v76, v31
v_sub_f32 v44, v44, v31
v_sub_f32 v77, v77, v31
v_sub_f32 v45, v45, v31
v_sub_f32 v78, v78, v31
v_sub_f32 v46, v46, v31
v_sub_f32 v79, v79, v31
v_sub_f32 v47, v47, v31
v_sub_f32 v92, v92, v31
v_sub_f32 v60, v60, v31
v_sub_f32 v93, v93, v31
v_sub_f32 v61, v61, v31
v_sub_f32 v94, v94, v31
v_sub_f32 v62, v62, v31
v_sub_f32 v95, v95, v31
v_sub_f32 v63, v63, v31
v_mul_f32 v19, v19, v32
v_accvgpr_read_b32 v33, a4
s_nop 0
v_mul_f32 v33, v33, v32
v_accvgpr_write_b32 a4, v33
v_accvgpr_read_b32 v33, a5
s_nop 0
v_mul_f32 v33, v33, v32
v_accvgpr_write_b32 a5, v33
v_accvgpr_read_b32 v33, a6
s_nop 0
v_mul_f32 v33, v33, v32
v_accvgpr_write_b32 a6, v33
v_accvgpr_read_b32 v33, a7
s_nop 0
v_mul_f32 v33, v33, v32
v_accvgpr_write_b32 a7, v33
v_accvgpr_read_b32 v33, a20
s_nop 0
v_mul_f32 v33, v33, v32
v_accvgpr_write_b32 a20, v33
v_accvgpr_read_b32 v33, a21
s_nop 0
v_mul_f32 v33, v33, v32
v_accvgpr_write_b32 a21, v33
v_accvgpr_read_b32 v33, a22
s_nop 0
v_mul_f32 v33, v33, v32
v_accvgpr_write_b32 a22, v33
v_accvgpr_read_b32 v33, a23
s_nop 0
v_mul_f32 v33, v33, v32
v_accvgpr_write_b32 a23, v33
v_accvgpr_read_b32 v33, a36
s_nop 0
v_mul_f32 v33, v33, v32
v_accvgpr_write_b32 a36, v33
v_accvgpr_read_b32 v33, a37
s_nop 0
v_mul_f32 v33, v33, v32
v_accvgpr_write_b32 a37, v33
v_accvgpr_read_b32 v33, a38
s_nop 0
v_mul_f32 v33, v33, v32
v_accvgpr_write_b32 a38, v33
v_accvgpr_read_b32 v33, a39
s_nop 0
v_mul_f32 v33, v33, v32
v_accvgpr_write_b32 a39, v33
v_accvgpr_read_b32 v33, a52
s_nop 0
v_mul_f32 v33, v33, v32
v_accvgpr_write_b32 a52, v33
v_accvgpr_read_b32 v33, a53
s_nop 0
v_mul_f32 v33, v33, v32
v_accvgpr_write_b32 a53, v33
v_accvgpr_read_b32 v33, a54
s_nop 0
v_mul_f32 v33, v33, v32
v_accvgpr_write_b32 a54, v33
v_accvgpr_read_b32 v33, a55
s_nop 0
v_mul_f32 v33, v33, v32
v_accvgpr_write_b32 a55, v33
v_accvgpr_read_b32 v33, a68
s_nop 0
v_mul_f32 v33, v33, v32
v_accvgpr_write_b32 a68, v33
v_accvgpr_read_b32 v33, a69
s_nop 0
v_mul_f32 v33, v33, v32
v_accvgpr_write_b32 a69, v33
v_accvgpr_read_b32 v33, a70
s_nop 0
v_mul_f32 v33, v33, v32
v_accvgpr_write_b32 a70, v33
v_accvgpr_read_b32 v33, a71
s_nop 0
v_mul_f32 v33, v33, v32
v_accvgpr_write_b32 a71, v33
v_accvgpr_read_b32 v33, a84
s_nop 0
v_mul_f32 v33, v33, v32
v_accvgpr_write_b32 a84, v33
v_accvgpr_read_b32 v33, a85
s_nop 0
v_mul_f32 v33, v33, v32
v_accvgpr_write_b32 a85, v33
v_accvgpr_read_b32 v33, a86
s_nop 0
v_mul_f32 v33, v33, v32
v_accvgpr_write_b32 a86, v33
v_accvgpr_read_b32 v33, a87
s_nop 0
v_mul_f32 v33, v33, v32
v_accvgpr_write_b32 a87, v33
v_accvgpr_read_b32 v33, a100
s_nop 0
v_mul_f32 v33, v33, v32
v_accvgpr_write_b32 a100, v33
v_accvgpr_read_b32 v33, a101
s_nop 0
v_mul_f32 v33, v33, v32
v_accvgpr_write_b32 a101, v33
v_accvgpr_read_b32 v33, a102
s_nop 0
v_mul_f32 v33, v33, v32
v_accvgpr_write_b32 a102, v33
v_accvgpr_read_b32 v33, a103
s_nop 0
v_mul_f32 v33, v33, v32
v_accvgpr_write_b32 a103, v33
v_accvgpr_read_b32 v33, a116
s_nop 0
v_mul_f32 v33, v33, v32
v_accvgpr_write_b32 a116, v33
v_accvgpr_read_b32 v33, a117
s_nop 0
v_mul_f32 v33, v33, v32
v_accvgpr_write_b32 a117, v33
v_accvgpr_read_b32 v33, a118
s_nop 0
v_mul_f32 v33, v33, v32
v_accvgpr_write_b32 a118, v33
v_accvgpr_read_b32 v33, a119
s_nop 0
v_mul_f32 v33, v33, v32
v_accvgpr_write_b32 a119, v33
v_max3_f32 v31, v80, v81, v82
v_max3_f32 v31, v31, v83, v96
v_max3_f32 v31, v31, v97, v98
v_max_f32 v31, v31, v99
v_mov_b32 v28, v31
s_nop 1
v_permlane32_swap_b32 v31, v28
s_nop 1
v_max_f32 v31, v31, v28
v_mov_b32 v28, v31
s_nop 1
v_permlane16_swap_b32 v31, v28
s_nop 1
v_max_f32 v31, v31, v28
v_max_f32 v31, 0, v31
v_exp_f32_e64 v32, -v31
v_sub_f32 v144, v144, v31
v_sub_f32 v145, v145, v31
v_sub_f32 v146, v146, v31
v_sub_f32 v147, v147, v31
v_sub_f32 v80, v80, v31
v_sub_f32 v48, v48, v31
v_sub_f32 v81, v81, v31
v_sub_f32 v49, v49, v31
v_sub_f32 v82, v82, v31
v_sub_f32 v50, v50, v31
v_sub_f32 v83, v83, v31
v_sub_f32 v51, v51, v31
v_sub_f32 v96, v96, v31
v_sub_f32 v64, v64, v31
v_sub_f32 v97, v97, v31
v_sub_f32 v65, v65, v31
v_sub_f32 v98, v98, v31
v_sub_f32 v66, v66, v31
v_sub_f32 v99, v99, v31
v_sub_f32 v67, v67, v31
v_mul_f32 v20, v20, v32
v_accvgpr_read_b32 v33, a8
s_nop 0
v_mul_f32 v33, v33, v32
v_accvgpr_write_b32 a8, v33
v_accvgpr_read_b32 v33, a9
s_nop 0
v_mul_f32 v33, v33, v32
v_accvgpr_write_b32 a9, v33
v_accvgpr_read_b32 v33, a10
s_nop 0
v_mul_f32 v33, v33, v32
v_accvgpr_write_b32 a10, v33
v_accvgpr_read_b32 v33, a11
s_nop 0
v_mul_f32 v33, v33, v32
v_accvgpr_write_b32 a11, v33
v_accvgpr_read_b32 v33, a24
s_nop 0
v_mul_f32 v33, v33, v32
v_accvgpr_write_b32 a24, v33
v_accvgpr_read_b32 v33, a25
s_nop 0
v_mul_f32 v33, v33, v32
v_accvgpr_write_b32 a25, v33
v_accvgpr_read_b32 v33, a26
s_nop 0
v_mul_f32 v33, v33, v32
v_accvgpr_write_b32 a26, v33
v_accvgpr_read_b32 v33, a27
s_nop 0
v_mul_f32 v33, v33, v32
v_accvgpr_write_b32 a27, v33
v_accvgpr_read_b32 v33, a40
s_nop 0
v_mul_f32 v33, v33, v32
v_accvgpr_write_b32 a40, v33
v_accvgpr_read_b32 v33, a41
s_nop 0
v_mul_f32 v33, v33, v32
v_accvgpr_write_b32 a41, v33
v_accvgpr_read_b32 v33, a42
s_nop 0
v_mul_f32 v33, v33, v32
v_accvgpr_write_b32 a42, v33
v_accvgpr_read_b32 v33, a43
s_nop 0
v_mul_f32 v33, v33, v32
v_accvgpr_write_b32 a43, v33
v_accvgpr_read_b32 v33, a56
s_nop 0
v_mul_f32 v33, v33, v32
v_accvgpr_write_b32 a56, v33
v_accvgpr_read_b32 v33, a57
s_nop 0
v_mul_f32 v33, v33, v32
v_accvgpr_write_b32 a57, v33
v_accvgpr_read_b32 v33, a58
s_nop 0
v_mul_f32 v33, v33, v32
v_accvgpr_write_b32 a58, v33
v_accvgpr_read_b32 v33, a59
s_nop 0
v_mul_f32 v33, v33, v32
v_accvgpr_write_b32 a59, v33
v_accvgpr_read_b32 v33, a72
s_nop 0
v_mul_f32 v33, v33, v32
v_accvgpr_write_b32 a72, v33
v_accvgpr_read_b32 v33, a73
s_nop 0
v_mul_f32 v33, v33, v32
v_accvgpr_write_b32 a73, v33
v_accvgpr_read_b32 v33, a74
s_nop 0
v_mul_f32 v33, v33, v32
v_accvgpr_write_b32 a74, v33
v_accvgpr_read_b32 v33, a75
s_nop 0
v_mul_f32 v33, v33, v32
v_accvgpr_write_b32 a75, v33
v_accvgpr_read_b32 v33, a88
s_nop 0
v_mul_f32 v33, v33, v32
v_accvgpr_write_b32 a88, v33
v_accvgpr_read_b32 v33, a89
s_nop 0
v_mul_f32 v33, v33, v32
v_accvgpr_write_b32 a89, v33
v_accvgpr_read_b32 v33, a90
s_nop 0
v_mul_f32 v33, v33, v32
v_accvgpr_write_b32 a90, v33
v_accvgpr_read_b32 v33, a91
s_nop 0
v_mul_f32 v33, v33, v32
v_accvgpr_write_b32 a91, v33
v_accvgpr_read_b32 v33, a104
s_nop 0
v_mul_f32 v33, v33, v32
v_accvgpr_write_b32 a104, v33
v_accvgpr_read_b32 v33, a105
s_nop 0
v_mul_f32 v33, v33, v32
v_accvgpr_write_b32 a105, v33
v_accvgpr_read_b32 v33, a106
s_nop 0
v_mul_f32 v33, v33, v32
v_accvgpr_write_b32 a106, v33
v_accvgpr_read_b32 v33, a107
s_nop 0
v_mul_f32 v33, v33, v32
v_accvgpr_write_b32 a107, v33
v_accvgpr_read_b32 v33, a120
s_nop 0
v_mul_f32 v33, v33, v32
v_accvgpr_write_b32 a120, v33
v_accvgpr_read_b32 v33, a121
s_nop 0
v_mul_f32 v33, v33, v32
v_accvgpr_write_b32 a121, v33
v_accvgpr_read_b32 v33, a122
s_nop 0
v_mul_f32 v33, v33, v32
v_accvgpr_write_b32 a122, v33
v_accvgpr_read_b32 v33, a123
s_nop 0
v_mul_f32 v33, v33, v32
v_accvgpr_write_b32 a123, v33
v_max3_f32 v31, v84, v85, v86
v_max3_f32 v31, v31, v87, v100
v_max3_f32 v31, v31, v101, v102
v_max_f32 v31, v31, v103
v_mov_b32 v28, v31
s_nop 1
v_permlane32_swap_b32 v31, v28
s_nop 1
v_max_f32 v31, v31, v28
v_mov_b32 v28, v31
s_nop 1
v_permlane16_swap_b32 v31, v28
s_nop 1
v_max_f32 v31, v31, v28
v_max_f32 v31, 0, v31
v_exp_f32_e64 v32, -v31
v_sub_f32 v148, v148, v31
v_sub_f32 v149, v149, v31
v_sub_f32 v150, v150, v31
v_sub_f32 v151, v151, v31
v_sub_f32 v84, v84, v31
v_sub_f32 v52, v52, v31
v_sub_f32 v85, v85, v31
v_sub_f32 v53, v53, v31
v_sub_f32 v86, v86, v31
v_sub_f32 v54, v54, v31
v_sub_f32 v87, v87, v31
v_sub_f32 v55, v55, v31
v_sub_f32 v100, v100, v31
v_sub_f32 v68, v68, v31
v_sub_f32 v101, v101, v31
v_sub_f32 v69, v69, v31
v_sub_f32 v102, v102, v31
v_sub_f32 v70, v70, v31
v_sub_f32 v103, v103, v31
v_sub_f32 v71, v71, v31
v_mul_f32 v21, v21, v32
v_accvgpr_read_b32 v33, a12
s_nop 0
v_mul_f32 v33, v33, v32
v_accvgpr_write_b32 a12, v33
v_accvgpr_read_b32 v33, a13
s_nop 0
v_mul_f32 v33, v33, v32
v_accvgpr_write_b32 a13, v33
v_accvgpr_read_b32 v33, a14
s_nop 0
v_mul_f32 v33, v33, v32
v_accvgpr_write_b32 a14, v33
v_accvgpr_read_b32 v33, a15
s_nop 0
v_mul_f32 v33, v33, v32
v_accvgpr_write_b32 a15, v33
v_accvgpr_read_b32 v33, a28
s_nop 0
v_mul_f32 v33, v33, v32
v_accvgpr_write_b32 a28, v33
v_accvgpr_read_b32 v33, a29
s_nop 0
v_mul_f32 v33, v33, v32
v_accvgpr_write_b32 a29, v33
v_accvgpr_read_b32 v33, a30
s_nop 0
v_mul_f32 v33, v33, v32
v_accvgpr_write_b32 a30, v33
v_accvgpr_read_b32 v33, a31
s_nop 0
v_mul_f32 v33, v33, v32
v_accvgpr_write_b32 a31, v33
v_accvgpr_read_b32 v33, a44
s_nop 0
v_mul_f32 v33, v33, v32
v_accvgpr_write_b32 a44, v33
v_accvgpr_read_b32 v33, a45
s_nop 0
v_mul_f32 v33, v33, v32
v_accvgpr_write_b32 a45, v33
v_accvgpr_read_b32 v33, a46
s_nop 0
v_mul_f32 v33, v33, v32
v_accvgpr_write_b32 a46, v33
v_accvgpr_read_b32 v33, a47
s_nop 0
v_mul_f32 v33, v33, v32
v_accvgpr_write_b32 a47, v33
v_accvgpr_read_b32 v33, a60
s_nop 0
v_mul_f32 v33, v33, v32
v_accvgpr_write_b32 a60, v33
v_accvgpr_read_b32 v33, a61
s_nop 0
v_mul_f32 v33, v33, v32
v_accvgpr_write_b32 a61, v33
v_accvgpr_read_b32 v33, a62
s_nop 0
v_mul_f32 v33, v33, v32
v_accvgpr_write_b32 a62, v33
v_accvgpr_read_b32 v33, a63
s_nop 0
v_mul_f32 v33, v33, v32
v_accvgpr_write_b32 a63, v33
v_accvgpr_read_b32 v33, a76
s_nop 0
v_mul_f32 v33, v33, v32
v_accvgpr_write_b32 a76, v33
v_accvgpr_read_b32 v33, a77
s_nop 0
v_mul_f32 v33, v33, v32
v_accvgpr_write_b32 a77, v33
v_accvgpr_read_b32 v33, a78
s_nop 0
v_mul_f32 v33, v33, v32
v_accvgpr_write_b32 a78, v33
v_accvgpr_read_b32 v33, a79
s_nop 0
v_mul_f32 v33, v33, v32
v_accvgpr_write_b32 a79, v33
v_accvgpr_read_b32 v33, a92
s_nop 0
v_mul_f32 v33, v33, v32
v_accvgpr_write_b32 a92, v33
v_accvgpr_read_b32 v33, a93
s_nop 0
v_mul_f32 v33, v33, v32
v_accvgpr_write_b32 a93, v33
v_accvgpr_read_b32 v33, a94
s_nop 0
v_mul_f32 v33, v33, v32
v_accvgpr_write_b32 a94, v33
v_accvgpr_read_b32 v33, a95
s_nop 0
v_mul_f32 v33, v33, v32
v_accvgpr_write_b32 a95, v33
v_accvgpr_read_b32 v33, a108
s_nop 0
v_mul_f32 v33, v33, v32
v_accvgpr_write_b32 a108, v33
v_accvgpr_read_b32 v33, a109
s_nop 0
v_mul_f32 v33, v33, v32
v_accvgpr_write_b32 a109, v33
v_accvgpr_read_b32 v33, a110
s_nop 0
v_mul_f32 v33, v33, v32
v_accvgpr_write_b32 a110, v33
v_accvgpr_read_b32 v33, a111
s_nop 0
v_mul_f32 v33, v33, v32
v_accvgpr_write_b32 a111, v33
v_accvgpr_read_b32 v33, a124
s_nop 0
v_mul_f32 v33, v33, v32
v_accvgpr_write_b32 a124, v33
v_accvgpr_read_b32 v33, a125
s_nop 0
v_mul_f32 v33, v33, v32
v_accvgpr_write_b32 a125, v33
v_accvgpr_read_b32 v33, a126
s_nop 0
v_mul_f32 v33, v33, v32
v_accvgpr_write_b32 a126, v33
v_accvgpr_read_b32 v33, a127
s_nop 0
v_mul_f32 v33, v33, v32
v_accvgpr_write_b32 a127, v33
v_exp_f32 v29, v72
v_exp_f32 v30, v73
s_nop 0
v_add_f32 v22, v29, v30
v_cvt_pk_bf16_f32 v120, v29, v30
v_exp_f32 v29, v74
v_exp_f32 v30, v75
s_nop 0
v_add_f32 v22, v22, v29
v_add_f32 v22, v22, v30
v_cvt_pk_bf16_f32 v121, v29, v30
v_exp_f32 v29, v88
v_exp_f32 v30, v89
s_nop 0
v_add_f32 v22, v22, v29
v_add_f32 v22, v22, v30
v_cvt_pk_bf16_f32 v122, v29, v30
v_exp_f32 v29, v90
v_exp_f32 v30, v91
s_nop 0
v_add_f32 v22, v22, v29
v_add_f32 v22, v22, v30
v_cvt_pk_bf16_f32 v123, v29, v30
v_exp_f32 v29, v76
v_exp_f32 v30, v77
s_nop 0
v_add_f32 v23, v29, v30
v_cvt_pk_bf16_f32 v124, v29, v30
v_exp_f32 v29, v78
v_exp_f32 v30, v79
s_nop 0
v_add_f32 v23, v23, v29
v_add_f32 v23, v23, v30
v_cvt_pk_bf16_f32 v125, v29, v30
v_exp_f32 v29, v92
v_exp_f32 v30, v93
s_nop 0
v_add_f32 v23, v23, v29
v_add_f32 v23, v23, v30
v_cvt_pk_bf16_f32 v126, v29, v30
v_exp_f32 v29, v94
v_exp_f32 v30, v95
s_nop 0
v_add_f32 v23, v23, v29
v_add_f32 v23, v23, v30
v_cvt_pk_bf16_f32 v127, v29, v30
v_exp_f32 v29, v80
v_exp_f32 v30, v81
s_nop 0
v_add_f32 v24, v29, v30
v_cvt_pk_bf16_f32 v128, v29, v30
v_exp_f32 v29, v82
v_exp_f32 v30, v83
s_nop 0
v_add_f32 v24, v24, v29
v_add_f32 v24, v24, v30
v_cvt_pk_bf16_f32 v129, v29, v30
v_exp_f32 v29, v96
v_exp_f32 v30, v97
s_nop 0
v_add_f32 v24, v24, v29
v_add_f32 v24, v24, v30
v_cvt_pk_bf16_f32 v130, v29, v30
v_exp_f32 v29, v98
v_exp_f32 v30, v99
s_nop 0
v_add_f32 v24, v24, v29
v_add_f32 v24, v24, v30
v_cvt_pk_bf16_f32 v131, v29, v30
v_exp_f32 v29, v84
v_exp_f32 v30, v85
s_nop 0
v_add_f32 v25, v29, v30
v_cvt_pk_bf16_f32 v132, v29, v30
v_exp_f32 v29, v86
v_exp_f32 v30, v87
s_nop 0
v_add_f32 v25, v25, v29
v_add_f32 v25, v25, v30
v_cvt_pk_bf16_f32 v133, v29, v30
v_exp_f32 v29, v100
v_exp_f32 v30, v101
s_nop 0
v_add_f32 v25, v25, v29
v_add_f32 v25, v25, v30
v_cvt_pk_bf16_f32 v134, v29, v30
v_exp_f32 v29, v102
v_exp_f32 v30, v103
s_nop 0
v_add_f32 v25, v25, v29
v_add_f32 v25, v25, v30
v_cvt_pk_bf16_f32 v135, v29, v30
s_nop 4
s_branch L_BACK_1
L_RARE_2:
s_nop 15
s_nop 15
v_max3_f32 v31, v40, v41, v42
v_max3_f32 v31, v31, v43, v56
v_max3_f32 v31, v31, v57, v58
v_max_f32 v31, v31, v59
v_mov_b32 v28, v31
s_nop 1
v_permlane32_swap_b32 v31, v28
s_nop 1
v_max_f32 v31, v31, v28
v_mov_b32 v28, v31
s_nop 1
v_permlane16_swap_b32 v31, v28
s_nop 1
v_max_f32 v31, v31, v28
v_max_f32 v31, 0, v31
v_exp_f32_e64 v32, -v31
v_sub_f32 v136, v136, v31
v_sub_f32 v137, v137, v31
v_sub_f32 v138, v138, v31
v_sub_f32 v139, v139, v31
v_sub_f32 v40, v40, v31
v_sub_f32 v72, v72, v31
v_sub_f32 v41, v41, v31
v_sub_f32 v73, v73, v31
v_sub_f32 v42, v42, v31
v_sub_f32 v74, v74, v31
v_sub_f32 v43, v43, v31
v_sub_f32 v75, v75, v31
v_sub_f32 v56, v56, v31
v_sub_f32 v88, v88, v31
v_sub_f32 v57, v57, v31
v_sub_f32 v89, v89, v31
v_sub_f32 v58, v58, v31
v_sub_f32 v90, v90, v31
v_sub_f32 v59, v59, v31
v_sub_f32 v91, v91, v31
v_mul_f32 v18, v18, v32
v_accvgpr_read_b32 v33, a0
s_nop 0
v_mul_f32 v33, v33, v32
v_accvgpr_write_b32 a0, v33
v_accvgpr_read_b32 v33, a1
s_nop 0
v_mul_f32 v33, v33, v32
v_accvgpr_write_b32 a1, v33
v_accvgpr_read_b32 v33, a2
s_nop 0
v_mul_f32 v33, v33, v32
v_accvgpr_write_b32 a2, v33
v_accvgpr_read_b32 v33, a3
s_nop 0
v_mul_f32 v33, v33, v32
v_accvgpr_write_b32 a3, v33
v_accvgpr_read_b32 v33, a16
s_nop 0
v_mul_f32 v33, v33, v32
v_accvgpr_write_b32 a16, v33
v_accvgpr_read_b32 v33, a17
s_nop 0
v_mul_f32 v33, v33, v32
v_accvgpr_write_b32 a17, v33
v_accvgpr_read_b32 v33, a18
s_nop 0
v_mul_f32 v33, v33, v32
v_accvgpr_write_b32 a18, v33
v_accvgpr_read_b32 v33, a19
s_nop 0
v_mul_f32 v33, v33, v32
v_accvgpr_write_b32 a19, v33
v_accvgpr_read_b32 v33, a32
s_nop 0
v_mul_f32 v33, v33, v32
v_accvgpr_write_b32 a32, v33
v_accvgpr_read_b32 v33, a33
s_nop 0
v_mul_f32 v33, v33, v32
v_accvgpr_write_b32 a33, v33
v_accvgpr_read_b32 v33, a34
s_nop 0
v_mul_f32 v33, v33, v32
v_accvgpr_write_b32 a34, v33
v_accvgpr_read_b32 v33, a35
s_nop 0
v_mul_f32 v33, v33, v32
v_accvgpr_write_b32 a35, v33
v_accvgpr_read_b32 v33, a48
s_nop 0
v_mul_f32 v33, v33, v32
v_accvgpr_write_b32 a48, v33
v_accvgpr_read_b32 v33, a49
s_nop 0
v_mul_f32 v33, v33, v32
v_accvgpr_write_b32 a49, v33
v_accvgpr_read_b32 v33, a50
s_nop 0
v_mul_f32 v33, v33, v32
v_accvgpr_write_b32 a50, v33
v_accvgpr_read_b32 v33, a51
s_nop 0
v_mul_f32 v33, v33, v32
v_accvgpr_write_b32 a51, v33
v_accvgpr_read_b32 v33, a64
s_nop 0
v_mul_f32 v33, v33, v32
v_accvgpr_write_b32 a64, v33
v_accvgpr_read_b32 v33, a65
s_nop 0
v_mul_f32 v33, v33, v32
v_accvgpr_write_b32 a65, v33
v_accvgpr_read_b32 v33, a66
s_nop 0
v_mul_f32 v33, v33, v32
v_accvgpr_write_b32 a66, v33
v_accvgpr_read_b32 v33, a67
s_nop 0
v_mul_f32 v33, v33, v32
v_accvgpr_write_b32 a67, v33
v_accvgpr_read_b32 v33, a80
s_nop 0
v_mul_f32 v33, v33, v32
v_accvgpr_write_b32 a80, v33
v_accvgpr_read_b32 v33, a81
s_nop 0
v_mul_f32 v33, v33, v32
v_accvgpr_write_b32 a81, v33
v_accvgpr_read_b32 v33, a82
s_nop 0
v_mul_f32 v33, v33, v32
v_accvgpr_write_b32 a82, v33
v_accvgpr_read_b32 v33, a83
s_nop 0
v_mul_f32 v33, v33, v32
v_accvgpr_write_b32 a83, v33
v_accvgpr_read_b32 v33, a96
s_nop 0
v_mul_f32 v33, v33, v32
v_accvgpr_write_b32 a96, v33
v_accvgpr_read_b32 v33, a97
s_nop 0
v_mul_f32 v33, v33, v32
v_accvgpr_write_b32 a97, v33
v_accvgpr_read_b32 v33, a98
s_nop 0
v_mul_f32 v33, v33, v32
v_accvgpr_write_b32 a98, v33
v_accvgpr_read_b32 v33, a99
s_nop 0
v_mul_f32 v33, v33, v32
v_accvgpr_write_b32 a99, v33
v_accvgpr_read_b32 v33, a112
s_nop 0
v_mul_f32 v33, v33, v32
v_accvgpr_write_b32 a112, v33
v_accvgpr_read_b32 v33, a113
s_nop 0
v_mul_f32 v33, v33, v32
v_accvgpr_write_b32 a113, v33
v_accvgpr_read_b32 v33, a114
s_nop 0
v_mul_f32 v33, v33, v32
v_accvgpr_write_b32 a114, v33
v_accvgpr_read_b32 v33, a115
s_nop 0
v_mul_f32 v33, v33, v32
v_accvgpr_write_b32 a115, v33
v_max3_f32 v31, v44, v45, v46
v_max3_f32 v31, v31, v47, v60
v_max3_f32 v31, v31, v61, v62
v_max_f32 v31, v31, v63
v_mov_b32 v28, v31
s_nop 1
v_permlane32_swap_b32 v31, v28
s_nop 1
v_max_f32 v31, v31, v28
v_mov_b32 v28, v31
s_nop 1
v_permlane16_swap_b32 v31, v28
s_nop 1
v_max_f32 v31, v31, v28
v_max_f32 v31, 0, v31
v_exp_f32_e64 v32, -v31
v_sub_f32 v140, v140, v31
v_sub_f32 v141, v141, v31
v_sub_f32 v142, v142, v31
v_sub_f32 v143, v143, v31
v_sub_f32 v44, v44, v31
v_sub_f32 v76, v76, v31
v_sub_f32 v45, v45, v31
v_sub_f32 v77, v77, v31
v_sub_f32 v46, v46, v31
v_sub_f32 v78, v78, v31
v_sub_f32 v47, v47, v31
v_sub_f32 v79, v79, v31
v_sub_f32 v60, v60, v31
v_sub_f32 v92, v92, v31
v_sub_f32 v61, v61, v31
v_sub_f32 v93, v93, v31
v_sub_f32 v62, v62, v31
v_sub_f32 v94, v94, v31
v_sub_f32 v63, v63, v31
v_sub_f32 v95, v95, v31
v_mul_f32 v19, v19, v32
v_accvgpr_read_b32 v33, a4
s_nop 0
v_mul_f32 v33, v33, v32
v_accvgpr_write_b32 a4, v33
v_accvgpr_read_b32 v33, a5
s_nop 0
v_mul_f32 v33, v33, v32
v_accvgpr_write_b32 a5, v33
v_accvgpr_read_b32 v33, a6
s_nop 0
v_mul_f32 v33, v33, v32
v_accvgpr_write_b32 a6, v33
v_accvgpr_read_b32 v33, a7
s_nop 0
v_mul_f32 v33, v33, v32
v_accvgpr_write_b32 a7, v33
v_accvgpr_read_b32 v33, a20
s_nop 0
v_mul_f32 v33, v33, v32
v_accvgpr_write_b32 a20, v33
v_accvgpr_read_b32 v33, a21
s_nop 0
v_mul_f32 v33, v33, v32
v_accvgpr_write_b32 a21, v33
v_accvgpr_read_b32 v33, a22
s_nop 0
v_mul_f32 v33, v33, v32
v_accvgpr_write_b32 a22, v33
v_accvgpr_read_b32 v33, a23
s_nop 0
v_mul_f32 v33, v33, v32
v_accvgpr_write_b32 a23, v33
v_accvgpr_read_b32 v33, a36
s_nop 0
v_mul_f32 v33, v33, v32
v_accvgpr_write_b32 a36, v33
v_accvgpr_read_b32 v33, a37
s_nop 0
v_mul_f32 v33, v33, v32
v_accvgpr_write_b32 a37, v33
v_accvgpr_read_b32 v33, a38
s_nop 0
v_mul_f32 v33, v33, v32
v_accvgpr_write_b32 a38, v33
v_accvgpr_read_b32 v33, a39
s_nop 0
v_mul_f32 v33, v33, v32
v_accvgpr_write_b32 a39, v33
v_accvgpr_read_b32 v33, a52
s_nop 0
v_mul_f32 v33, v33, v32
v_accvgpr_write_b32 a52, v33
v_accvgpr_read_b32 v33, a53
s_nop 0
v_mul_f32 v33, v33, v32
v_accvgpr_write_b32 a53, v33
v_accvgpr_read_b32 v33, a54
s_nop 0
v_mul_f32 v33, v33, v32
v_accvgpr_write_b32 a54, v33
v_accvgpr_read_b32 v33, a55
s_nop 0
v_mul_f32 v33, v33, v32
v_accvgpr_write_b32 a55, v33
v_accvgpr_read_b32 v33, a68
s_nop 0
v_mul_f32 v33, v33, v32
v_accvgpr_write_b32 a68, v33
v_accvgpr_read_b32 v33, a69
s_nop 0
v_mul_f32 v33, v33, v32
v_accvgpr_write_b32 a69, v33
v_accvgpr_read_b32 v33, a70
s_nop 0
v_mul_f32 v33, v33, v32
v_accvgpr_write_b32 a70, v33
v_accvgpr_read_b32 v33, a71
s_nop 0
v_mul_f32 v33, v33, v32
v_accvgpr_write_b32 a71, v33
v_accvgpr_read_b32 v33, a84
s_nop 0
v_mul_f32 v33, v33, v32
v_accvgpr_write_b32 a84, v33
v_accvgpr_read_b32 v33, a85
s_nop 0
v_mul_f32 v33, v33, v32
v_accvgpr_write_b32 a85, v33
v_accvgpr_read_b32 v33, a86
s_nop 0
v_mul_f32 v33, v33, v32
v_accvgpr_write_b32 a86, v33
v_accvgpr_read_b32 v33, a87
s_nop 0
v_mul_f32 v33, v33, v32
v_accvgpr_write_b32 a87, v33
v_accvgpr_read_b32 v33, a100
s_nop 0
v_mul_f32 v33, v33, v32
v_accvgpr_write_b32 a100, v33
v_accvgpr_read_b32 v33, a101
s_nop 0
v_mul_f32 v33, v33, v32
v_accvgpr_write_b32 a101, v33
v_accvgpr_read_b32 v33, a102
s_nop 0
v_mul_f32 v33, v33, v32
v_accvgpr_write_b32 a102, v33
v_accvgpr_read_b32 v33, a103
s_nop 0
v_mul_f32 v33, v33, v32
v_accvgpr_write_b32 a103, v33
v_accvgpr_read_b32 v33, a116
s_nop 0
v_mul_f32 v33, v33, v32
v_accvgpr_write_b32 a116, v33
v_accvgpr_read_b32 v33, a117
s_nop 0
v_mul_f32 v33, v33, v32
v_accvgpr_write_b32 a117, v33
v_accvgpr_read_b32 v33, a118
s_nop 0
v_mul_f32 v33, v33, v32
v_accvgpr_write_b32 a118, v33
v_accvgpr_read_b32 v33, a119
s_nop 0
v_mul_f32 v33, v33, v32
v_accvgpr_write_b32 a119, v33
v_max3_f32 v31, v48, v49, v50
v_max3_f32 v31, v31, v51, v64
v_max3_f32 v31, v31, v65, v66
v_max_f32 v31, v31, v67
v_mov_b32 v28, v31
s_nop 1
v_permlane32_swap_b32 v31, v28
s_nop 1
v_max_f32 v31, v31, v28
v_mov_b32 v28, v31
s_nop 1
v_permlane16_swap_b32 v31, v28
s_nop 1
v_max_f32 v31, v31, v28
v_max_f32 v31, 0, v31
v_exp_f32_e64 v32, -v31
v_sub_f32 v144, v144, v31
v_sub_f32 v145, v145, v31
v_sub_f32 v146, v146, v31
v_sub_f32 v147, v147, v31
v_sub_f32 v48, v48, v31
v_sub_f32 v80, v80, v31
v_sub_f32 v49, v49, v31
v_sub_f32 v81, v81, v31
v_sub_f32 v50, v50, v31
v_sub_f32 v82, v82, v31
v_sub_f32 v51, v51, v31
v_sub_f32 v83, v83, v31
v_sub_f32 v64, v64, v31
v_sub_f32 v96, v96, v31
v_sub_f32 v65, v65, v31
v_sub_f32 v97, v97, v31
v_sub_f32 v66, v66, v31
v_sub_f32 v98, v98, v31
v_sub_f32 v67, v67, v31
v_sub_f32 v99, v99, v31
v_mul_f32 v20, v20, v32
v_accvgpr_read_b32 v33, a8
s_nop 0
v_mul_f32 v33, v33, v32
v_accvgpr_write_b32 a8, v33
v_accvgpr_read_b32 v33, a9
s_nop 0
v_mul_f32 v33, v33, v32
v_accvgpr_write_b32 a9, v33
v_accvgpr_read_b32 v33, a10
s_nop 0
v_mul_f32 v33, v33, v32
v_accvgpr_write_b32 a10, v33
v_accvgpr_read_b32 v33, a11
s_nop 0
v_mul_f32 v33, v33, v32
v_accvgpr_write_b32 a11, v33
v_accvgpr_read_b32 v33, a24
s_nop 0
v_mul_f32 v33, v33, v32
v_accvgpr_write_b32 a24, v33
v_accvgpr_read_b32 v33, a25
s_nop 0
v_mul_f32 v33, v33, v32
v_accvgpr_write_b32 a25, v33
v_accvgpr_read_b32 v33, a26
s_nop 0
v_mul_f32 v33, v33, v32
v_accvgpr_write_b32 a26, v33
v_accvgpr_read_b32 v33, a27
s_nop 0
v_mul_f32 v33, v33, v32
v_accvgpr_write_b32 a27, v33
v_accvgpr_read_b32 v33, a40
s_nop 0
v_mul_f32 v33, v33, v32
v_accvgpr_write_b32 a40, v33
v_accvgpr_read_b32 v33, a41
s_nop 0
v_mul_f32 v33, v33, v32
v_accvgpr_write_b32 a41, v33
v_accvgpr_read_b32 v33, a42
s_nop 0
v_mul_f32 v33, v33, v32
v_accvgpr_write_b32 a42, v33
v_accvgpr_read_b32 v33, a43
s_nop 0
v_mul_f32 v33, v33, v32
v_accvgpr_write_b32 a43, v33
v_accvgpr_read_b32 v33, a56
s_nop 0
v_mul_f32 v33, v33, v32
v_accvgpr_write_b32 a56, v33
v_accvgpr_read_b32 v33, a57
s_nop 0
v_mul_f32 v33, v33, v32
v_accvgpr_write_b32 a57, v33
v_accvgpr_read_b32 v33, a58
s_nop 0
v_mul_f32 v33, v33, v32
v_accvgpr_write_b32 a58, v33
v_accvgpr_read_b32 v33, a59
s_nop 0
v_mul_f32 v33, v33, v32
v_accvgpr_write_b32 a59, v33
v_accvgpr_read_b32 v33, a72
s_nop 0
v_mul_f32 v33, v33, v32
v_accvgpr_write_b32 a72, v33
v_accvgpr_read_b32 v33, a73
s_nop 0
v_mul_f32 v33, v33, v32
v_accvgpr_write_b32 a73, v33
v_accvgpr_read_b32 v33, a74
s_nop 0
v_mul_f32 v33, v33, v32
v_accvgpr_write_b32 a74, v33
v_accvgpr_read_b32 v33, a75
s_nop 0
v_mul_f32 v33, v33, v32
v_accvgpr_write_b32 a75, v33
v_accvgpr_read_b32 v33, a88
s_nop 0
v_mul_f32 v33, v33, v32
v_accvgpr_write_b32 a88, v33
v_accvgpr_read_b32 v33, a89
s_nop 0
v_mul_f32 v33, v33, v32
v_accvgpr_write_b32 a89, v33
v_accvgpr_read_b32 v33, a90
s_nop 0
v_mul_f32 v33, v33, v32
v_accvgpr_write_b32 a90, v33
v_accvgpr_read_b32 v33, a91
s_nop 0
v_mul_f32 v33, v33, v32
v_accvgpr_write_b32 a91, v33
v_accvgpr_read_b32 v33, a104
s_nop 0
v_mul_f32 v33, v33, v32
v_accvgpr_write_b32 a104, v33
v_accvgpr_read_b32 v33, a105
s_nop 0
v_mul_f32 v33, v33, v32
v_accvgpr_write_b32 a105, v33
v_accvgpr_read_b32 v33, a106
s_nop 0
v_mul_f32 v33, v33, v32
v_accvgpr_write_b32 a106, v33
v_accvgpr_read_b32 v33, a107
s_nop 0
v_mul_f32 v33, v33, v32
v_accvgpr_write_b32 a107, v33
v_accvgpr_read_b32 v33, a120
s_nop 0
v_mul_f32 v33, v33, v32
v_accvgpr_write_b32 a120, v33
v_accvgpr_read_b32 v33, a121
s_nop 0
v_mul_f32 v33, v33, v32
v_accvgpr_write_b32 a121, v33
v_accvgpr_read_b32 v33, a122
s_nop 0
v_mul_f32 v33, v33, v32
v_accvgpr_write_b32 a122, v33
v_accvgpr_read_b32 v33, a123
s_nop 0
v_mul_f32 v33, v33, v32
v_accvgpr_write_b32 a123, v33
v_max3_f32 v31, v52, v53, v54
v_max3_f32 v31, v31, v55, v68
v_max3_f32 v31, v31, v69, v70
v_max_f32 v31, v31, v71
v_mov_b32 v28, v31
s_nop 1
v_permlane32_swap_b32 v31, v28
s_nop 1
v_max_f32 v31, v31, v28
v_mov_b32 v28, v31
s_nop 1
v_permlane16_swap_b32 v31, v28
s_nop 1
v_max_f32 v31, v31, v28
v_max_f32 v31, 0, v31
v_exp_f32_e64 v32, -v31
v_sub_f32 v148, v148, v31
v_sub_f32 v149, v149, v31
v_sub_f32 v150, v150, v31
v_sub_f32 v151, v151, v31
v_sub_f32 v52, v52, v31
v_sub_f32 v84, v84, v31
v_sub_f32 v53, v53, v31
v_sub_f32 v85, v85, v31
v_sub_f32 v54, v54, v31
v_sub_f32 v86, v86, v31
v_sub_f32 v55, v55, v31
v_sub_f32 v87, v87, v31
v_sub_f32 v68, v68, v31
v_sub_f32 v100, v100, v31
v_sub_f32 v69, v69, v31
v_sub_f32 v101, v101, v31
v_sub_f32 v70, v70, v31
v_sub_f32 v102, v102, v31
v_sub_f32 v71, v71, v31
v_sub_f32 v103, v103, v31
v_mul_f32 v21, v21, v32
v_accvgpr_read_b32 v33, a12
s_nop 0
v_mul_f32 v33, v33, v32
v_accvgpr_write_b32 a12, v33
v_accvgpr_read_b32 v33, a13
s_nop 0
v_mul_f32 v33, v33, v32
v_accvgpr_write_b32 a13, v33
v_accvgpr_read_b32 v33, a14
s_nop 0
v_mul_f32 v33, v33, v32
v_accvgpr_write_b32 a14, v33
v_accvgpr_read_b32 v33, a15
s_nop 0
v_mul_f32 v33, v33, v32
v_accvgpr_write_b32 a15, v33
v_accvgpr_read_b32 v33, a28
s_nop 0
v_mul_f32 v33, v33, v32
v_accvgpr_write_b32 a28, v33
v_accvgpr_read_b32 v33, a29
s_nop 0
v_mul_f32 v33, v33, v32
v_accvgpr_write_b32 a29, v33
v_accvgpr_read_b32 v33, a30
s_nop 0
v_mul_f32 v33, v33, v32
v_accvgpr_write_b32 a30, v33
v_accvgpr_read_b32 v33, a31
s_nop 0
v_mul_f32 v33, v33, v32
v_accvgpr_write_b32 a31, v33
v_accvgpr_read_b32 v33, a44
s_nop 0
v_mul_f32 v33, v33, v32
v_accvgpr_write_b32 a44, v33
v_accvgpr_read_b32 v33, a45
s_nop 0
v_mul_f32 v33, v33, v32
v_accvgpr_write_b32 a45, v33
v_accvgpr_read_b32 v33, a46
s_nop 0
v_mul_f32 v33, v33, v32
v_accvgpr_write_b32 a46, v33
v_accvgpr_read_b32 v33, a47
s_nop 0
v_mul_f32 v33, v33, v32
v_accvgpr_write_b32 a47, v33
v_accvgpr_read_b32 v33, a60
s_nop 0
v_mul_f32 v33, v33, v32
v_accvgpr_write_b32 a60, v33
v_accvgpr_read_b32 v33, a61
s_nop 0
v_mul_f32 v33, v33, v32
v_accvgpr_write_b32 a61, v33
v_accvgpr_read_b32 v33, a62
s_nop 0
v_mul_f32 v33, v33, v32
v_accvgpr_write_b32 a62, v33
v_accvgpr_read_b32 v33, a63
s_nop 0
v_mul_f32 v33, v33, v32
v_accvgpr_write_b32 a63, v33
v_accvgpr_read_b32 v33, a76
s_nop 0
v_mul_f32 v33, v33, v32
v_accvgpr_write_b32 a76, v33
v_accvgpr_read_b32 v33, a77
s_nop 0
v_mul_f32 v33, v33, v32
v_accvgpr_write_b32 a77, v33
v_accvgpr_read_b32 v33, a78
s_nop 0
v_mul_f32 v33, v33, v32
v_accvgpr_write_b32 a78, v33
v_accvgpr_read_b32 v33, a79
s_nop 0
v_mul_f32 v33, v33, v32
v_accvgpr_write_b32 a79, v33
v_accvgpr_read_b32 v33, a92
s_nop 0
v_mul_f32 v33, v33, v32
v_accvgpr_write_b32 a92, v33
v_accvgpr_read_b32 v33, a93
s_nop 0
v_mul_f32 v33, v33, v32
v_accvgpr_write_b32 a93, v33
v_accvgpr_read_b32 v33, a94
s_nop 0
v_mul_f32 v33, v33, v32
v_accvgpr_write_b32 a94, v33
v_accvgpr_read_b32 v33, a95
s_nop 0
v_mul_f32 v33, v33, v32
v_accvgpr_write_b32 a95, v33
v_accvgpr_read_b32 v33, a108
s_nop 0
v_mul_f32 v33, v33, v32
v_accvgpr_write_b32 a108, v33
v_accvgpr_read_b32 v33, a109
s_nop 0
v_mul_f32 v33, v33, v32
v_accvgpr_write_b32 a109, v33
v_accvgpr_read_b32 v33, a110
s_nop 0
v_mul_f32 v33, v33, v32
v_accvgpr_write_b32 a110, v33
v_accvgpr_read_b32 v33, a111
s_nop 0
v_mul_f32 v33, v33, v32
v_accvgpr_write_b32 a111, v33
v_accvgpr_read_b32 v33, a124
s_nop 0
v_mul_f32 v33, v33, v32
v_accvgpr_write_b32 a124, v33
v_accvgpr_read_b32 v33, a125
s_nop 0
v_mul_f32 v33, v33, v32
v_accvgpr_write_b32 a125, v33
v_accvgpr_read_b32 v33, a126
s_nop 0
v_mul_f32 v33, v33, v32
v_accvgpr_write_b32 a126, v33
v_accvgpr_read_b32 v33, a127
s_nop 0
v_mul_f32 v33, v33, v32
v_accvgpr_write_b32 a127, v33
v_exp_f32 v29, v40
v_exp_f32 v30, v41
s_nop 0
v_add_f32 v22, v29, v30
v_cvt_pk_bf16_f32 v104, v29, v30
v_exp_f32 v29, v42
v_exp_f32 v30, v43
s_nop 0
v_add_f32 v22, v22, v29
v_add_f32 v22, v22, v30
v_cvt_pk_bf16_f32 v105, v29, v30
v_exp_f32 v29, v56
v_exp_f32 v30, v57
s_nop 0
v_add_f32 v22, v22, v29
v_add_f32 v22, v22, v30
v_cvt_pk_bf16_f32 v106, v29, v30
v_exp_f32 v29, v58
v_exp_f32 v30, v59
s_nop 0
v_add_f32 v22, v22, v29
v_add_f32 v22, v22, v30
v_cvt_pk_bf16_f32 v107, v29, v30
v_exp_f32 v29, v44
v_exp_f32 v30, v45
s_nop 0
v_add_f32 v23, v29, v30
v_cvt_pk_bf16_f32 v108, v29, v30
v_exp_f32 v29, v46
v_exp_f32 v30, v47
s_nop 0
v_add_f32 v23, v23, v29
v_add_f32 v23, v23, v30
v_cvt_pk_bf16_f32 v109, v29, v30
v_exp_f32 v29, v60
v_exp_f32 v30, v61
s_nop 0
v_add_f32 v23, v23, v29
v_add_f32 v23, v23, v30
v_cvt_pk_bf16_f32 v110, v29, v30
v_exp_f32 v29, v62
v_exp_f32 v30, v63
s_nop 0
v_add_f32 v23, v23, v29
v_add_f32 v23, v23, v30
v_cvt_pk_bf16_f32 v111, v29, v30
v_exp_f32 v29, v48
v_exp_f32 v30, v49
s_nop 0
v_add_f32 v24, v29, v30
v_cvt_pk_bf16_f32 v112, v29, v30
v_exp_f32 v29, v50
v_exp_f32 v30, v51
s_nop 0
v_add_f32 v24, v24, v29
v_add_f32 v24, v24, v30
v_cvt_pk_bf16_f32 v113, v29, v30
v_exp_f32 v29, v64
v_exp_f32 v30, v65
s_nop 0
v_add_f32 v24, v24, v29
v_add_f32 v24, v24, v30
v_cvt_pk_bf16_f32 v114, v29, v30
v_exp_f32 v29, v66
v_exp_f32 v30, v67
s_nop 0
v_add_f32 v24, v24, v29
v_add_f32 v24, v24, v30
v_cvt_pk_bf16_f32 v115, v29, v30
v_exp_f32 v29, v52
v_exp_f32 v30, v53
s_nop 0
v_add_f32 v25, v29, v30
v_cvt_pk_bf16_f32 v116, v29, v30
v_exp_f32 v29, v54
v_exp_f32 v30, v55
s_nop 0
v_add_f32 v25, v25, v29
v_add_f32 v25, v25, v30
v_cvt_pk_bf16_f32 v117, v29, v30
v_exp_f32 v29, v68
v_exp_f32 v30, v69
s_nop 0
v_add_f32 v25, v25, v29
v_add_f32 v25, v25, v30
v_cvt_pk_bf16_f32 v118, v29, v30
v_exp_f32 v29, v70
v_exp_f32 v30, v71
s_nop 0
v_add_f32 v25, v25, v29
v_add_f32 v25, v25, v30
v_cvt_pk_bf16_f32 v119, v29, v30
s_nop 4
s_branch L_BACK_2
L_RARE_3:
s_nop 15
s_nop 15
v_max3_f32 v31, v72, v73, v74
v_max3_f32 v31, v31, v75, v88
v_max3_f32 v31, v31, v89, v90
v_max_f32 v31, v31, v91
v_mov_b32 v28, v31
s_nop 1
v_permlane32_swap_b32 v31, v28
s_nop 1
v_max_f32 v31, v31, v28
v_mov_b32 v28, v31
s_nop 1
v_permlane16_swap_b32 v31, v28
s_nop 1
v_max_f32 v31, v31, v28
v_max_f32 v31, 0, v31
v_exp_f32_e64 v32, -v31
v_sub_f32 v136, v136, v31
v_sub_f32 v137, v137, v31
v_sub_f32 v138, v138, v31
v_sub_f32 v139, v139, v31
v_sub_f32 v72, v72, v31
v_sub_f32 v40, v40, v31
v_sub_f32 v73, v73, v31
v_sub_f32 v41, v41, v31
v_sub_f32 v74, v74, v31
v_sub_f32 v42, v42, v31
v_sub_f32 v75, v75, v31
v_sub_f32 v43, v43, v31
v_sub_f32 v88, v88, v31
v_sub_f32 v56, v56, v31
v_sub_f32 v89, v89, v31
v_sub_f32 v57, v57, v31
v_sub_f32 v90, v90, v31
v_sub_f32 v58, v58, v31
v_sub_f32 v91, v91, v31
v_sub_f32 v59, v59, v31
v_mul_f32 v18, v18, v32
v_accvgpr_read_b32 v33, a0
s_nop 0
v_mul_f32 v33, v33, v32
v_accvgpr_write_b32 a0, v33
v_accvgpr_read_b32 v33, a1
s_nop 0
v_mul_f32 v33, v33, v32
v_accvgpr_write_b32 a1, v33
v_accvgpr_read_b32 v33, a2
s_nop 0
v_mul_f32 v33, v33, v32
v_accvgpr_write_b32 a2, v33
v_accvgpr_read_b32 v33, a3
s_nop 0
v_mul_f32 v33, v33, v32
v_accvgpr_write_b32 a3, v33
v_accvgpr_read_b32 v33, a16
s_nop 0
v_mul_f32 v33, v33, v32
v_accvgpr_write_b32 a16, v33
v_accvgpr_read_b32 v33, a17
s_nop 0
v_mul_f32 v33, v33, v32
v_accvgpr_write_b32 a17, v33
v_accvgpr_read_b32 v33, a18
s_nop 0
v_mul_f32 v33, v33, v32
v_accvgpr_write_b32 a18, v33
v_accvgpr_read_b32 v33, a19
s_nop 0
v_mul_f32 v33, v33, v32
v_accvgpr_write_b32 a19, v33
v_accvgpr_read_b32 v33, a32
s_nop 0
v_mul_f32 v33, v33, v32
v_accvgpr_write_b32 a32, v33
v_accvgpr_read_b32 v33, a33
s_nop 0
v_mul_f32 v33, v33, v32
v_accvgpr_write_b32 a33, v33
v_accvgpr_read_b32 v33, a34
s_nop 0
v_mul_f32 v33, v33, v32
v_accvgpr_write_b32 a34, v33
v_accvgpr_read_b32 v33, a35
s_nop 0
v_mul_f32 v33, v33, v32
v_accvgpr_write_b32 a35, v33
v_accvgpr_read_b32 v33, a48
s_nop 0
v_mul_f32 v33, v33, v32
v_accvgpr_write_b32 a48, v33
v_accvgpr_read_b32 v33, a49
s_nop 0
v_mul_f32 v33, v33, v32
v_accvgpr_write_b32 a49, v33
v_accvgpr_read_b32 v33, a50
s_nop 0
v_mul_f32 v33, v33, v32
v_accvgpr_write_b32 a50, v33
v_accvgpr_read_b32 v33, a51
s_nop 0
v_mul_f32 v33, v33, v32
v_accvgpr_write_b32 a51, v33
v_accvgpr_read_b32 v33, a64
s_nop 0
v_mul_f32 v33, v33, v32
v_accvgpr_write_b32 a64, v33
v_accvgpr_read_b32 v33, a65
s_nop 0
v_mul_f32 v33, v33, v32
v_accvgpr_write_b32 a65, v33
v_accvgpr_read_b32 v33, a66
s_nop 0
v_mul_f32 v33, v33, v32
v_accvgpr_write_b32 a66, v33
v_accvgpr_read_b32 v33, a67
s_nop 0
v_mul_f32 v33, v33, v32
v_accvgpr_write_b32 a67, v33
v_accvgpr_read_b32 v33, a80
s_nop 0
v_mul_f32 v33, v33, v32
v_accvgpr_write_b32 a80, v33
v_accvgpr_read_b32 v33, a81
s_nop 0
v_mul_f32 v33, v33, v32
v_accvgpr_write_b32 a81, v33
v_accvgpr_read_b32 v33, a82
s_nop 0
v_mul_f32 v33, v33, v32
v_accvgpr_write_b32 a82, v33
v_accvgpr_read_b32 v33, a83
s_nop 0
v_mul_f32 v33, v33, v32
v_accvgpr_write_b32 a83, v33
v_accvgpr_read_b32 v33, a96
s_nop 0
v_mul_f32 v33, v33, v32
v_accvgpr_write_b32 a96, v33
v_accvgpr_read_b32 v33, a97
s_nop 0
v_mul_f32 v33, v33, v32
v_accvgpr_write_b32 a97, v33
v_accvgpr_read_b32 v33, a98
s_nop 0
v_mul_f32 v33, v33, v32
v_accvgpr_write_b32 a98, v33
v_accvgpr_read_b32 v33, a99
s_nop 0
v_mul_f32 v33, v33, v32
v_accvgpr_write_b32 a99, v33
v_accvgpr_read_b32 v33, a112
s_nop 0
v_mul_f32 v33, v33, v32
v_accvgpr_write_b32 a112, v33
v_accvgpr_read_b32 v33, a113
s_nop 0
v_mul_f32 v33, v33, v32
v_accvgpr_write_b32 a113, v33
v_accvgpr_read_b32 v33, a114
s_nop 0
v_mul_f32 v33, v33, v32
v_accvgpr_write_b32 a114, v33
v_accvgpr_read_b32 v33, a115
s_nop 0
v_mul_f32 v33, v33, v32
v_accvgpr_write_b32 a115, v33
v_max3_f32 v31, v76, v77, v78
v_max3_f32 v31, v31, v79, v92
v_max3_f32 v31, v31, v93, v94
v_max_f32 v31, v31, v95
v_mov_b32 v28, v31
s_nop 1
v_permlane32_swap_b32 v31, v28
s_nop 1
v_max_f32 v31, v31, v28
v_mov_b32 v28, v31
s_nop 1
v_permlane16_swap_b32 v31, v28
s_nop 1
v_max_f32 v31, v31, v28
v_max_f32 v31, 0, v31
v_exp_f32_e64 v32, -v31
v_sub_f32 v140, v140, v31
v_sub_f32 v141, v141, v31
v_sub_f32 v142, v142, v31
v_sub_f32 v143, v143, v31
v_sub_f32 v76, v76, v31
v_sub_f32 v44, v44, v31
v_sub_f32 v77, v77, v31
v_sub_f32 v45, v45, v31
v_sub_f32 v78, v78, v31
v_sub_f32 v46, v46, v31
v_sub_f32 v79, v79, v31
v_sub_f32 v47, v47, v31
v_sub_f32 v92, v92, v31
v_sub_f32 v60, v60, v31
v_sub_f32 v93, v93, v31
v_sub_f32 v61, v61, v31
v_sub_f32 v94, v94, v31
v_sub_f32 v62, v62, v31
v_sub_f32 v95, v95, v31
v_sub_f32 v63, v63, v31
v_mul_f32 v19, v19, v32
v_accvgpr_read_b32 v33, a4
s_nop 0
v_mul_f32 v33, v33, v32
v_accvgpr_write_b32 a4, v33
v_accvgpr_read_b32 v33, a5
s_nop 0
v_mul_f32 v33, v33, v32
v_accvgpr_write_b32 a5, v33
v_accvgpr_read_b32 v33, a6
s_nop 0
v_mul_f32 v33, v33, v32
v_accvgpr_write_b32 a6, v33
v_accvgpr_read_b32 v33, a7
s_nop 0
v_mul_f32 v33, v33, v32
v_accvgpr_write_b32 a7, v33
v_accvgpr_read_b32 v33, a20
s_nop 0
v_mul_f32 v33, v33, v32
v_accvgpr_write_b32 a20, v33
v_accvgpr_read_b32 v33, a21
s_nop 0
v_mul_f32 v33, v33, v32
v_accvgpr_write_b32 a21, v33
v_accvgpr_read_b32 v33, a22
s_nop 0
v_mul_f32 v33, v33, v32
v_accvgpr_write_b32 a22, v33
v_accvgpr_read_b32 v33, a23
s_nop 0
v_mul_f32 v33, v33, v32
v_accvgpr_write_b32 a23, v33
v_accvgpr_read_b32 v33, a36
s_nop 0
v_mul_f32 v33, v33, v32
v_accvgpr_write_b32 a36, v33
v_accvgpr_read_b32 v33, a37
s_nop 0
v_mul_f32 v33, v33, v32
v_accvgpr_write_b32 a37, v33
v_accvgpr_read_b32 v33, a38
s_nop 0
v_mul_f32 v33, v33, v32
v_accvgpr_write_b32 a38, v33
v_accvgpr_read_b32 v33, a39
s_nop 0
v_mul_f32 v33, v33, v32
v_accvgpr_write_b32 a39, v33
v_accvgpr_read_b32 v33, a52
s_nop 0
v_mul_f32 v33, v33, v32
v_accvgpr_write_b32 a52, v33
v_accvgpr_read_b32 v33, a53
s_nop 0
v_mul_f32 v33, v33, v32
v_accvgpr_write_b32 a53, v33
v_accvgpr_read_b32 v33, a54
s_nop 0
v_mul_f32 v33, v33, v32
v_accvgpr_write_b32 a54, v33
v_accvgpr_read_b32 v33, a55
s_nop 0
v_mul_f32 v33, v33, v32
v_accvgpr_write_b32 a55, v33
v_accvgpr_read_b32 v33, a68
s_nop 0
v_mul_f32 v33, v33, v32
v_accvgpr_write_b32 a68, v33
v_accvgpr_read_b32 v33, a69
s_nop 0
v_mul_f32 v33, v33, v32
v_accvgpr_write_b32 a69, v33
v_accvgpr_read_b32 v33, a70
s_nop 0
v_mul_f32 v33, v33, v32
v_accvgpr_write_b32 a70, v33
v_accvgpr_read_b32 v33, a71
s_nop 0
v_mul_f32 v33, v33, v32
v_accvgpr_write_b32 a71, v33
v_accvgpr_read_b32 v33, a84
s_nop 0
v_mul_f32 v33, v33, v32
v_accvgpr_write_b32 a84, v33
v_accvgpr_read_b32 v33, a85
s_nop 0
v_mul_f32 v33, v33, v32
v_accvgpr_write_b32 a85, v33
v_accvgpr_read_b32 v33, a86
s_nop 0
v_mul_f32 v33, v33, v32
v_accvgpr_write_b32 a86, v33
v_accvgpr_read_b32 v33, a87
s_nop 0
v_mul_f32 v33, v33, v32
v_accvgpr_write_b32 a87, v33
v_accvgpr_read_b32 v33, a100
s_nop 0
v_mul_f32 v33, v33, v32
v_accvgpr_write_b32 a100, v33
v_accvgpr_read_b32 v33, a101
s_nop 0
v_mul_f32 v33, v33, v32
v_accvgpr_write_b32 a101, v33
v_accvgpr_read_b32 v33, a102
s_nop 0
v_mul_f32 v33, v33, v32
v_accvgpr_write_b32 a102, v33
v_accvgpr_read_b32 v33, a103
s_nop 0
v_mul_f32 v33, v33, v32
v_accvgpr_write_b32 a103, v33
v_accvgpr_read_b32 v33, a116
s_nop 0
v_mul_f32 v33, v33, v32
v_accvgpr_write_b32 a116, v33
v_accvgpr_read_b32 v33, a117
s_nop 0
v_mul_f32 v33, v33, v32
v_accvgpr_write_b32 a117, v33
v_accvgpr_read_b32 v33, a118
s_nop 0
v_mul_f32 v33, v33, v32
v_accvgpr_write_b32 a118, v33
v_accvgpr_read_b32 v33, a119
s_nop 0
v_mul_f32 v33, v33, v32
v_accvgpr_write_b32 a119, v33
v_max3_f32 v31, v80, v81, v82
v_max3_f32 v31, v31, v83, v96
v_max3_f32 v31, v31, v97, v98
v_max_f32 v31, v31, v99
v_mov_b32 v28, v31
s_nop 1
v_permlane32_swap_b32 v31, v28
s_nop 1
v_max_f32 v31, v31, v28
v_mov_b32 v28, v31
s_nop 1
v_permlane16_swap_b32 v31, v28
s_nop 1
v_max_f32 v31, v31, v28
v_max_f32 v31, 0, v31
v_exp_f32_e64 v32, -v31
v_sub_f32 v144, v144, v31
v_sub_f32 v145, v145, v31
v_sub_f32 v146, v146, v31
v_sub_f32 v147, v147, v31
v_sub_f32 v80, v80, v31
v_sub_f32 v48, v48, v31
v_sub_f32 v81, v81, v31
v_sub_f32 v49, v49, v31
v_sub_f32 v82, v82, v31
v_sub_f32 v50, v50, v31
v_sub_f32 v83, v83, v31
v_sub_f32 v51, v51, v31
v_sub_f32 v96, v96, v31
v_sub_f32 v64, v64, v31
v_sub_f32 v97, v97, v31
v_sub_f32 v65, v65, v31
v_sub_f32 v98, v98, v31
v_sub_f32 v66, v66, v31
v_sub_f32 v99, v99, v31
v_sub_f32 v67, v67, v31
v_mul_f32 v20, v20, v32
v_accvgpr_read_b32 v33, a8
s_nop 0
v_mul_f32 v33, v33, v32
v_accvgpr_write_b32 a8, v33
v_accvgpr_read_b32 v33, a9
s_nop 0
v_mul_f32 v33, v33, v32
v_accvgpr_write_b32 a9, v33
v_accvgpr_read_b32 v33, a10
s_nop 0
v_mul_f32 v33, v33, v32
v_accvgpr_write_b32 a10, v33
v_accvgpr_read_b32 v33, a11
s_nop 0
v_mul_f32 v33, v33, v32
v_accvgpr_write_b32 a11, v33
v_accvgpr_read_b32 v33, a24
s_nop 0
v_mul_f32 v33, v33, v32
v_accvgpr_write_b32 a24, v33
v_accvgpr_read_b32 v33, a25
s_nop 0
v_mul_f32 v33, v33, v32
v_accvgpr_write_b32 a25, v33
v_accvgpr_read_b32 v33, a26
s_nop 0
v_mul_f32 v33, v33, v32
v_accvgpr_write_b32 a26, v33
v_accvgpr_read_b32 v33, a27
s_nop 0
v_mul_f32 v33, v33, v32
v_accvgpr_write_b32 a27, v33
v_accvgpr_read_b32 v33, a40
s_nop 0
v_mul_f32 v33, v33, v32
v_accvgpr_write_b32 a40, v33
v_accvgpr_read_b32 v33, a41
s_nop 0
v_mul_f32 v33, v33, v32
v_accvgpr_write_b32 a41, v33
v_accvgpr_read_b32 v33, a42
s_nop 0
v_mul_f32 v33, v33, v32
v_accvgpr_write_b32 a42, v33
v_accvgpr_read_b32 v33, a43
s_nop 0
v_mul_f32 v33, v33, v32
v_accvgpr_write_b32 a43, v33
v_accvgpr_read_b32 v33, a56
s_nop 0
v_mul_f32 v33, v33, v32
v_accvgpr_write_b32 a56, v33
v_accvgpr_read_b32 v33, a57
s_nop 0
v_mul_f32 v33, v33, v32
v_accvgpr_write_b32 a57, v33
v_accvgpr_read_b32 v33, a58
s_nop 0
v_mul_f32 v33, v33, v32
v_accvgpr_write_b32 a58, v33
v_accvgpr_read_b32 v33, a59
s_nop 0
v_mul_f32 v33, v33, v32
v_accvgpr_write_b32 a59, v33
v_accvgpr_read_b32 v33, a72
s_nop 0
v_mul_f32 v33, v33, v32
v_accvgpr_write_b32 a72, v33
v_accvgpr_read_b32 v33, a73
s_nop 0
v_mul_f32 v33, v33, v32
v_accvgpr_write_b32 a73, v33
v_accvgpr_read_b32 v33, a74
s_nop 0
v_mul_f32 v33, v33, v32
v_accvgpr_write_b32 a74, v33
v_accvgpr_read_b32 v33, a75
s_nop 0
v_mul_f32 v33, v33, v32
v_accvgpr_write_b32 a75, v33
v_accvgpr_read_b32 v33, a88
s_nop 0
v_mul_f32 v33, v33, v32
v_accvgpr_write_b32 a88, v33
v_accvgpr_read_b32 v33, a89
s_nop 0
v_mul_f32 v33, v33, v32
v_accvgpr_write_b32 a89, v33
v_accvgpr_read_b32 v33, a90
s_nop 0
v_mul_f32 v33, v33, v32
v_accvgpr_write_b32 a90, v33
v_accvgpr_read_b32 v33, a91
s_nop 0
v_mul_f32 v33, v33, v32
v_accvgpr_write_b32 a91, v33
v_accvgpr_read_b32 v33, a104
s_nop 0
v_mul_f32 v33, v33, v32
v_accvgpr_write_b32 a104, v33
v_accvgpr_read_b32 v33, a105
s_nop 0
v_mul_f32 v33, v33, v32
v_accvgpr_write_b32 a105, v33
v_accvgpr_read_b32 v33, a106
s_nop 0
v_mul_f32 v33, v33, v32
v_accvgpr_write_b32 a106, v33
v_accvgpr_read_b32 v33, a107
s_nop 0
v_mul_f32 v33, v33, v32
v_accvgpr_write_b32 a107, v33
v_accvgpr_read_b32 v33, a120
s_nop 0
v_mul_f32 v33, v33, v32
v_accvgpr_write_b32 a120, v33
v_accvgpr_read_b32 v33, a121
s_nop 0
v_mul_f32 v33, v33, v32
v_accvgpr_write_b32 a121, v33
v_accvgpr_read_b32 v33, a122
s_nop 0
v_mul_f32 v33, v33, v32
v_accvgpr_write_b32 a122, v33
v_accvgpr_read_b32 v33, a123
s_nop 0
v_mul_f32 v33, v33, v32
v_accvgpr_write_b32 a123, v33
v_max3_f32 v31, v84, v85, v86
v_max3_f32 v31, v31, v87, v100
v_max3_f32 v31, v31, v101, v102
v_max_f32 v31, v31, v103
v_mov_b32 v28, v31
s_nop 1
v_permlane32_swap_b32 v31, v28
s_nop 1
v_max_f32 v31, v31, v28
v_mov_b32 v28, v31
s_nop 1
v_permlane16_swap_b32 v31, v28
s_nop 1
v_max_f32 v31, v31, v28
v_max_f32 v31, 0, v31
v_exp_f32_e64 v32, -v31
v_sub_f32 v148, v148, v31
v_sub_f32 v149, v149, v31
v_sub_f32 v150, v150, v31
v_sub_f32 v151, v151, v31
v_sub_f32 v84, v84, v31
v_sub_f32 v52, v52, v31
v_sub_f32 v85, v85, v31
v_sub_f32 v53, v53, v31
v_sub_f32 v86, v86, v31
v_sub_f32 v54, v54, v31
v_sub_f32 v87, v87, v31
v_sub_f32 v55, v55, v31
v_sub_f32 v100, v100, v31
v_sub_f32 v68, v68, v31
v_sub_f32 v101, v101, v31
v_sub_f32 v69, v69, v31
v_sub_f32 v102, v102, v31
v_sub_f32 v70, v70, v31
v_sub_f32 v103, v103, v31
v_sub_f32 v71, v71, v31
v_mul_f32 v21, v21, v32
v_accvgpr_read_b32 v33, a12
s_nop 0
v_mul_f32 v33, v33, v32
v_accvgpr_write_b32 a12, v33
v_accvgpr_read_b32 v33, a13
s_nop 0
v_mul_f32 v33, v33, v32
v_accvgpr_write_b32 a13, v33
v_accvgpr_read_b32 v33, a14
s_nop 0
v_mul_f32 v33, v33, v32
v_accvgpr_write_b32 a14, v33
v_accvgpr_read_b32 v33, a15
s_nop 0
v_mul_f32 v33, v33, v32
v_accvgpr_write_b32 a15, v33
v_accvgpr_read_b32 v33, a28
s_nop 0
v_mul_f32 v33, v33, v32
v_accvgpr_write_b32 a28, v33
v_accvgpr_read_b32 v33, a29
s_nop 0
v_mul_f32 v33, v33, v32
v_accvgpr_write_b32 a29, v33
v_accvgpr_read_b32 v33, a30
s_nop 0
v_mul_f32 v33, v33, v32
v_accvgpr_write_b32 a30, v33
v_accvgpr_read_b32 v33, a31
s_nop 0
v_mul_f32 v33, v33, v32
v_accvgpr_write_b32 a31, v33
v_accvgpr_read_b32 v33, a44
s_nop 0
v_mul_f32 v33, v33, v32
v_accvgpr_write_b32 a44, v33
v_accvgpr_read_b32 v33, a45
s_nop 0
v_mul_f32 v33, v33, v32
v_accvgpr_write_b32 a45, v33
v_accvgpr_read_b32 v33, a46
s_nop 0
v_mul_f32 v33, v33, v32
v_accvgpr_write_b32 a46, v33
v_accvgpr_read_b32 v33, a47
s_nop 0
v_mul_f32 v33, v33, v32
v_accvgpr_write_b32 a47, v33
v_accvgpr_read_b32 v33, a60
s_nop 0
v_mul_f32 v33, v33, v32
v_accvgpr_write_b32 a60, v33
v_accvgpr_read_b32 v33, a61
s_nop 0
v_mul_f32 v33, v33, v32
v_accvgpr_write_b32 a61, v33
v_accvgpr_read_b32 v33, a62
s_nop 0
v_mul_f32 v33, v33, v32
v_accvgpr_write_b32 a62, v33
v_accvgpr_read_b32 v33, a63
s_nop 0
v_mul_f32 v33, v33, v32
v_accvgpr_write_b32 a63, v33
v_accvgpr_read_b32 v33, a76
s_nop 0
v_mul_f32 v33, v33, v32
v_accvgpr_write_b32 a76, v33
v_accvgpr_read_b32 v33, a77
s_nop 0
v_mul_f32 v33, v33, v32
v_accvgpr_write_b32 a77, v33
v_accvgpr_read_b32 v33, a78
s_nop 0
v_mul_f32 v33, v33, v32
v_accvgpr_write_b32 a78, v33
v_accvgpr_read_b32 v33, a79
s_nop 0
v_mul_f32 v33, v33, v32
v_accvgpr_write_b32 a79, v33
v_accvgpr_read_b32 v33, a92
s_nop 0
v_mul_f32 v33, v33, v32
v_accvgpr_write_b32 a92, v33
v_accvgpr_read_b32 v33, a93
s_nop 0
v_mul_f32 v33, v33, v32
v_accvgpr_write_b32 a93, v33
v_accvgpr_read_b32 v33, a94
s_nop 0
v_mul_f32 v33, v33, v32
v_accvgpr_write_b32 a94, v33
v_accvgpr_read_b32 v33, a95
s_nop 0
v_mul_f32 v33, v33, v32
v_accvgpr_write_b32 a95, v33
v_accvgpr_read_b32 v33, a108
s_nop 0
v_mul_f32 v33, v33, v32
v_accvgpr_write_b32 a108, v33
v_accvgpr_read_b32 v33, a109
s_nop 0
v_mul_f32 v33, v33, v32
v_accvgpr_write_b32 a109, v33
v_accvgpr_read_b32 v33, a110
s_nop 0
v_mul_f32 v33, v33, v32
v_accvgpr_write_b32 a110, v33
v_accvgpr_read_b32 v33, a111
s_nop 0
v_mul_f32 v33, v33, v32
v_accvgpr_write_b32 a111, v33
v_accvgpr_read_b32 v33, a124
s_nop 0
v_mul_f32 v33, v33, v32
v_accvgpr_write_b32 a124, v33
v_accvgpr_read_b32 v33, a125
s_nop 0
v_mul_f32 v33, v33, v32
v_accvgpr_write_b32 a125, v33
v_accvgpr_read_b32 v33, a126
s_nop 0
v_mul_f32 v33, v33, v32
v_accvgpr_write_b32 a126, v33
v_accvgpr_read_b32 v33, a127
s_nop 0
v_mul_f32 v33, v33, v32
v_accvgpr_write_b32 a127, v33
v_exp_f32 v29, v72
v_exp_f32 v30, v73
s_nop 0
v_add_f32 v22, v29, v30
v_cvt_pk_bf16_f32 v120, v29, v30
v_exp_f32 v29, v74
v_exp_f32 v30, v75
s_nop 0
v_add_f32 v22, v22, v29
v_add_f32 v22, v22, v30
v_cvt_pk_bf16_f32 v121, v29, v30
v_exp_f32 v29, v88
v_exp_f32 v30, v89
s_nop 0
v_add_f32 v22, v22, v29
v_add_f32 v22, v22, v30
v_cvt_pk_bf16_f32 v122, v29, v30
v_exp_f32 v29, v90
v_exp_f32 v30, v91
s_nop 0
v_add_f32 v22, v22, v29
v_add_f32 v22, v22, v30
v_cvt_pk_bf16_f32 v123, v29, v30
v_exp_f32 v29, v76
v_exp_f32 v30, v77
s_nop 0
v_add_f32 v23, v29, v30
v_cvt_pk_bf16_f32 v124, v29, v30
v_exp_f32 v29, v78
v_exp_f32 v30, v79
s_nop 0
v_add_f32 v23, v23, v29
v_add_f32 v23, v23, v30
v_cvt_pk_bf16_f32 v125, v29, v30
v_exp_f32 v29, v92
v_exp_f32 v30, v93
s_nop 0
v_add_f32 v23, v23, v29
v_add_f32 v23, v23, v30
v_cvt_pk_bf16_f32 v126, v29, v30
v_exp_f32 v29, v94
v_exp_f32 v30, v95
s_nop 0
v_add_f32 v23, v23, v29
v_add_f32 v23, v23, v30
v_cvt_pk_bf16_f32 v127, v29, v30
v_exp_f32 v29, v80
v_exp_f32 v30, v81
s_nop 0
v_add_f32 v24, v29, v30
v_cvt_pk_bf16_f32 v128, v29, v30
v_exp_f32 v29, v82
v_exp_f32 v30, v83
s_nop 0
v_add_f32 v24, v24, v29
v_add_f32 v24, v24, v30
v_cvt_pk_bf16_f32 v129, v29, v30
v_exp_f32 v29, v96
v_exp_f32 v30, v97
s_nop 0
v_add_f32 v24, v24, v29
v_add_f32 v24, v24, v30
v_cvt_pk_bf16_f32 v130, v29, v30
v_exp_f32 v29, v98
v_exp_f32 v30, v99
s_nop 0
v_add_f32 v24, v24, v29
v_add_f32 v24, v24, v30
v_cvt_pk_bf16_f32 v131, v29, v30
v_exp_f32 v29, v84
v_exp_f32 v30, v85
s_nop 0
v_add_f32 v25, v29, v30
v_cvt_pk_bf16_f32 v132, v29, v30
v_exp_f32 v29, v86
v_exp_f32 v30, v87
s_nop 0
v_add_f32 v25, v25, v29
v_add_f32 v25, v25, v30
v_cvt_pk_bf16_f32 v133, v29, v30
v_exp_f32 v29, v100
v_exp_f32 v30, v101
s_nop 0
v_add_f32 v25, v25, v29
v_add_f32 v25, v25, v30
v_cvt_pk_bf16_f32 v134, v29, v30
v_exp_f32 v29, v102
v_exp_f32 v30, v103
s_nop 0
v_add_f32 v25, v25, v29
v_add_f32 v25, v25, v30
v_cvt_pk_bf16_f32 v135, v29, v30
s_nop 4
s_branch L_BACK_3
L_END:
s_endpgm
.section .rodata,"a"
.p2align 6
.amdhsa_kernel standalone__gqa_softmax__prompt_kernel
  .amdhsa_next_free_vgpr 512
  .amdhsa_next_free_sgpr 102
  .amdhsa_accum_offset 256
  .amdhsa_group_segment_fixed_size 0
  .amdhsa_kernarg_size 48
  .amdhsa_user_sgpr_count 2
  .amdhsa_user_sgpr_kernarg_segment_ptr 1
  .amdhsa_system_sgpr_workgroup_id_x 1
.end_amdhsa_kernel
```
